```python
import torch

def _softmax(x, axis=-1):
    return torch.softmax(x, dim=axis)
def _gelu(x):
    return torch.nn.functional.gelu(x, approximate="tanh")
def _silu(x):
    return torch.nn.functional.silu(x)
def _sigmoid(x):
    return torch.sigmoid(x)
def _layernorm(x, axis=-1, eps=1e-5):
    m = x.mean(dim=axis, keepdim=True)
    v = x.var(dim=axis, keepdim=True, unbiased=False)
    return (x - m) / torch.sqrt(v + eps)
def _scatter_add(tgt, idx, src, axis=0):
    return tgt.clone().index_add_(axis, idx, src)
def _segment_sum(src, seg, n):
    out = torch.zeros((n,) + src.shape[1:], dtype=src.dtype)
    return out.index_add_(0, seg, src)
def _pad(x, pw):
    flat = tuple(v for pair in reversed(pw) for v in pair)
    return torch.nn.functional.pad(x, flat)

kernel_name = 'parallel_sum__mha_block_cached__glu_gated_glu__decode'

def setup_inputs():

    _w = (lambda a: (lambda t: t.to(torch.bfloat16) if t.is_floating_point() else t)(torch.as_tensor(a)))
    def _A_setup():
        B, Sq, D = 8, 1, 448
        H, Sk, Dh = 16, 4096, 256
        return {
            "x": _w((lambda *s: torch.randn(*s, dtype=torch.bfloat16) * 0.05)(B, Sq, D)),
            "k_cache": _w((lambda *s: torch.randn(*s, dtype=torch.bfloat16) * 3.2)(B, H, Sk, Dh)),
            "v_cache": _w((lambda *s: torch.randn(*s, dtype=torch.bfloat16) * 1.6)(B, H, Sk, Dh)),
            "wq": _w((lambda *s: torch.randn(*s, dtype=torch.bfloat16) * 3.2)(D, H * Dh) * (D ** -0.5)),
            "wo": _w((lambda *s: torch.randn(*s, dtype=torch.bfloat16) * 1.6)(H * Dh, D) * ((H * Dh) ** -0.5)),
        }
    _A_in = _A_setup()

    def _B_setup():
        B, S, D, F = 8, 1, 448, 1792
        return {
            "x": _w((lambda *s: torch.randn(*s, dtype=torch.bfloat16) * 0.05)(B, S, D)),
            "w_gate": _w((lambda *s: torch.randn(*s, dtype=torch.bfloat16) * 0.4)(D, F)),
            "w_up": _w((lambda *s: torch.randn(*s, dtype=torch.bfloat16) * 0.05)(D, F)),
            "w_down": _w((lambda *s: torch.randn(*s, dtype=torch.bfloat16) * 0.05)(F, D)),
        }
    _B_in = _B_setup()

    return {
        "A_x": _A_in["x"],
        "A_k_cache": _A_in["k_cache"],
        "A_v_cache": _A_in["v_cache"],
        "A_wq": _A_in["wq"],
        "A_wo": _A_in["wo"],
        "B_x": _B_in["x"],
        "B_w_gate": _B_in["w_gate"],
        "B_w_up": _B_in["w_up"],
        "B_w_down": _B_in["w_down"],
    }

def reference(A_x, A_k_cache, A_v_cache, A_wq, A_wo, B_x, B_w_gate, B_w_up, B_w_down):
    def _A_ref(x, k_cache, v_cache, wq, wo):
        B, Sq, D = x.shape
        H, Dh = 16, 256
        q = (lambda x, *d: x.permute(*d))((x @ wq).reshape(B, Sq, H, Dh), 0, 2, 1, 3)
        scores = torch.einsum("bhqd,bhkd->bhqk", q, k_cache) * (Dh ** -0.5)
        p = _softmax(scores, axis=-1)
        o = torch.einsum("bhqk,bhkd->bhqd", p, v_cache)
        return (lambda x, *d: x.permute(*d))(o, 0, 2, 1, 3).reshape(B, Sq, H * Dh) @ wo

    def _B_ref(x, w_gate, w_up, w_down):
        g = torch.einsum("bsd,df->bsf", x, w_gate)
        u = torch.einsum("bsd,df->bsf", x, w_up)
        h = _sigmoid(g) * u
        return torch.einsum("bsf,fd->bsd", h, w_down)

    x = A_x
    xn = _layernorm(x, axis=-1)
    return x + _A_ref(xn, A_k_cache, A_v_cache, A_wq, A_wo) + _B_ref(xn, B_w_gate, B_w_up, B_w_down)
```

```asm
; @launch grid=(256,1,1) block=(512,1,1) lds=64256
.amdgcn_target "amdgcn-amd-amdhsa--gfx950"
.text
.globl parallel_sum__mha_block_cached__glu_gated_glu__decode_kernel
.p2align 8
.type parallel_sum__mha_block_cached__glu_gated_glu__decode_kernel,@function
parallel_sum__mha_block_cached__glu_gated_glu__decode_kernel:
  s_cmp_ge_u32 s2, 256
  s_cbranch_scc1 L_end
  s_load_dwordx16 s[4:19], s[0:1], 0
  s_load_dwordx8 s[20:27], s[0:1], 64
  v_and_b32 v1, 63, v0
  v_lshrrev_b32 v5, 6, v0
  v_lshlrev_b32 v2, 4, v1
  v_readfirstlane_b32 s60, v5
  s_and_b32 s67, s2, 7
  s_bfe_u32 s68, s2, 0x10003
  s_bfe_u32 s63, s2, 0x10004
  s_lshr_b32 s61, s2, 5
  s_lshl_b32 s70, s68, 1
  s_add_u32 s70, s70, 3
  s_mul_i32 s70, s70, s63
  s_xor_b32 s67, s67, s70
  s_lshl_b32 s62, s67, 1
  s_add_u32 s62, s62, s68
  s_lshl_b32 s64, s62, 1
  s_add_u32 s64, s64, s63
  s_mov_b32 s69, 0xffff0000
  v_lshrrev_b32 v5, 1, v1
  v_and_b32 v6, 1, v1
  v_lshlrev_b32 v3, 13, v5
  v_lshl_add_u32 v3, v6, 4, v3
  s_lshl_b32 s3, s61, 4
  s_add_u32 s3, s3, s62
  s_lshl_b32 s67, s3, 21
  s_mul_i32 s68, s60, 896
  s_lshl_b32 s93, s63, 3
  s_add_u32 s93, s93, s61
  s_lshl_b32 s94, s62, 4
  s_add_u32 s94, s94, s93
  s_lshl_b32 s70, s94, 5
  s_sub_u32 s71, 3670016, s70
  s_lshl_b32 s66, s60, 12
  s_mul_i32 s88, s63, 851968
  s_add_u32 s66, s66, s88
  s_sub_u32 s74, 7, s60
  s_lshl_b32 s65, s74, 19
  s_add_u32 s91, s65, 0x40000
  s_add_u32 s88, s66, 32768
  s_add_u32 s89, s66, 0x10000
  s_add_u32 s90, s66, 98304
  s_add_u32 s75, s66, 0x20000
  s_add_u32 s76, s66, 163840
  s_waitcnt lgkmcnt(0)
  s_add_u32 s44, s4, s68
  s_addc_u32 s45, s5, 0
  s_mov_b32 s46, 896
  s_mov_b32 s47, 0x00020000
  buffer_load_dwordx4 v[24:27], v2, s[44:47], 0 offen
  s_add_u32 s36, s10, s70
  s_addc_u32 s37, s11, 0
  s_mov_b32 s38, s71
  s_mov_b32 s39, 0x00020000
  buffer_load_dwordx4 v[56:59], v3, s[36:39], s65 offen
  buffer_load_dwordx4 v[60:63], v3, s[36:39], s91 offen
  s_cmp_lg_u32 s60, 0
  s_cbranch_scc1 L_nonon
  s_memrealtime s[100:101]
  s_lshl_b32 s68, s62, 3
  v_mov_b32 v5, s68
  v_mov_b32 v21, 0
  s_waitcnt lgkmcnt(0)
  s_or_b32 s100, s100, 1
  v_mov_b32 v20, s100
  s_mov_b64 exec, 1
  global_atomic_cmpswap v20, v5, v[20:21], s[24:25] sc0 sc1
  s_mov_b64 exec, -1
L_nonon:
  s_add_u32 s28, s6, s67
  s_addc_u32 s29, s7, 0
  s_mov_b32 s30, 2097152
  s_mov_b32 s31, 0x00020000
  s_add_u32 s32, s8, s67
  s_addc_u32 s33, s9, 0
  s_mov_b32 s34, 2097152
  s_mov_b32 s35, 0x00020000
  buffer_load_dwordx4 v[64:67], v2, s[28:31], s66 offen offset:0 nt
  buffer_load_dwordx4 v[68:71], v2, s[28:31], s66 offen offset:1024 nt
  buffer_load_dwordx4 v[72:75], v2, s[28:31], s66 offen offset:2048 nt
  buffer_load_dwordx4 v[76:79], v2, s[28:31], s66 offen offset:3072 nt
  s_mov_b32 s56, s26
  s_mov_b32 s57, s27
  s_mov_b32 s58, 4194304
  s_mov_b32 s59, 0x00020000
  s_lshl_b32 s95, s61, 5
  s_add_u32 s95, s95, s64
  s_lshl_b32 s95, s95, 12
  v_mov_b32 v12, 0
  v_mov_b32 v13, 0
  v_mov_b32 v14, 0
  v_mov_b32 v15, 0
  v_mov_b32 v16, 0
  v_mov_b32 v17, 0
  v_mov_b32 v18, 0
  v_mov_b32 v19, 0
  s_cmp_lt_u32 s60, 4
  s_cselect_b32 s40, s16, s18
  s_cselect_b32 s41, s17, s19
  s_mov_b32 s42, 1605632
  s_mov_b32 s43, 0x00020000
  s_mov_b32 s48, s12
  s_mov_b32 s49, s13
  s_mov_b32 s50, 3670016
  s_mov_b32 s51, 0x00020000
  s_mov_b32 s52, s20
  s_mov_b32 s53, s21
  s_mov_b32 s54, 1605632
  s_mov_b32 s55, 0x00020000
  v_cmp_gt_u32 vcc, 56, v1
  v_mov_b32 v5, 47296
  ds_write_b128 v5, v[12:15]
  s_waitcnt vmcnt(6)
  v_lshlrev_b32 v28, 16, v24
  v_and_b32 v29, s69, v24
  v_lshlrev_b32 v30, 16, v25
  v_and_b32 v31, s69, v25
  v_lshlrev_b32 v32, 16, v26
  v_and_b32 v33, s69, v26
  v_lshlrev_b32 v34, 16, v27
  v_and_b32 v35, s69, v27
  v_add_f32 v36, v28, v29
  v_add_f32 v37, v30, v31
  v_add_f32 v38, v32, v33
  v_add_f32 v39, v34, v35
  v_add_f32 v36, v36, v37
  v_add_f32 v38, v38, v39
  v_add_f32 v36, v36, v38
  s_nop 1
  v_add_f32_dpp v36, v36, v36 quad_perm:[1,0,3,2] row_mask:0xf bank_mask:0xf
  s_nop 1
  v_add_f32_dpp v36, v36, v36 quad_perm:[2,3,0,1] row_mask:0xf bank_mask:0xf
  s_nop 1
  buffer_load_dwordx4 v[80:83], v2, s[32:35], s66 offen offset:0 nt
  v_add_f32_dpp v36, v36, v36 row_half_mirror row_mask:0xf bank_mask:0xf
  s_nop 1
  v_add_f32_dpp v36, v36, v36 row_mirror row_mask:0xf bank_mask:0xf
  s_nop 1
  v_add_f32_dpp v36, v36, v36 row_bcast:15 row_mask:0xa bank_mask:0xf
  s_nop 1
  v_add_f32_dpp v36, v36, v36 row_bcast:31 row_mask:0xc bank_mask:0xf
  s_nop 0
  v_readlane_b32 s67, v36, 63
  s_nop 1
  v_mov_b32 v37, s67
  v_mul_f32 v37, 0x3b124925, v37
  v_sub_f32 v40, v28, v37
  v_sub_f32 v41, v29, v37
  v_sub_f32 v42, v30, v37
  v_sub_f32 v43, v31, v37
  v_sub_f32 v44, v32, v37
  v_sub_f32 v45, v33, v37
  v_sub_f32 v46, v34, v37
  v_sub_f32 v47, v35, v37
  buffer_load_dwordx4 v[84:87], v2, s[32:35], s66 offen offset:1024 nt
  v_mul_f32 v38, v40, v40
  v_fmac_f32 v38, v41, v41
  v_fmac_f32 v38, v42, v42
  v_fmac_f32 v38, v43, v43
  v_fmac_f32 v38, v44, v44
  v_fmac_f32 v38, v45, v45
  v_fmac_f32 v38, v46, v46
  v_fmac_f32 v38, v47, v47
  v_cndmask_b32 v38, 0, v38, vcc
  s_nop 1
  v_add_f32_dpp v38, v38, v38 quad_perm:[1,0,3,2] row_mask:0xf bank_mask:0xf
  s_nop 1
  v_add_f32_dpp v38, v38, v38 quad_perm:[2,3,0,1] row_mask:0xf bank_mask:0xf
  s_nop 1
  v_add_f32_dpp v38, v38, v38 row_half_mirror row_mask:0xf bank_mask:0xf
  s_nop 1
  v_add_f32_dpp v38, v38, v38 row_mirror row_mask:0xf bank_mask:0xf
  s_nop 1
  v_add_f32_dpp v38, v38, v38 row_bcast:15 row_mask:0xa bank_mask:0xf
  s_nop 1
  buffer_load_dwordx4 v[88:91], v2, s[32:35], s66 offen offset:2048 nt
  v_add_f32_dpp v38, v38, v38 row_bcast:31 row_mask:0xc bank_mask:0xf
  s_nop 0
  v_readlane_b32 s67, v38, 63
  v_cvt_pk_bf16_f32 v37, v37, v37
  v_and_b32 v37, s69, v37
  v_mov_b32 v38, s67
  v_mul_f32 v38, 0x3b124925, v38
  v_cvt_pk_bf16_f32 v38, v38, v38
  v_and_b32 v38, s69, v38
  v_add_f32 v38, 0x3727c5ac, v38
  v_cvt_pk_bf16_f32 v38, v38, v38
  v_and_b32 v38, s69, v38
  v_sqrt_f32 v38, v38
  v_sub_f32 v40, v28, v37
  v_sub_f32 v41, v29, v37
  v_sub_f32 v42, v30, v37
  v_sub_f32 v43, v31, v37
  v_sub_f32 v44, v32, v37
  v_sub_f32 v45, v33, v37
  v_sub_f32 v46, v34, v37
  buffer_load_dwordx4 v[92:95], v2, s[32:35], s66 offen offset:3072 nt
  v_sub_f32 v47, v35, v37
  v_cvt_pk_bf16_f32 v38, v38, v38
  v_and_b32 v38, s69, v38
  v_rcp_f32 v38, v38
  v_cvt_pk_bf16_f32 v24, v40, v41
  v_cvt_pk_bf16_f32 v25, v42, v43
  v_cvt_pk_bf16_f32 v26, v44, v45
  v_cvt_pk_bf16_f32 v27, v46, v47
  v_lshlrev_b32 v40, 16, v24
  v_and_b32 v41, s69, v24
  v_lshlrev_b32 v42, 16, v25
  v_and_b32 v43, s69, v25
  v_lshlrev_b32 v44, 16, v26
  v_and_b32 v45, s69, v26
  v_lshlrev_b32 v46, 16, v27
  v_and_b32 v47, s69, v27
  v_mul_f32 v40, v40, v38
  v_mul_f32 v41, v41, v38
  v_mul_f32 v42, v42, v38
  v_mul_f32 v43, v43, v38
  buffer_load_dwordx4 v[96:99], v2, s[28:31], s88 offen offset:0 nt
  v_mul_f32 v44, v44, v38
  v_mul_f32 v45, v45, v38
  v_mul_f32 v46, v46, v38
  v_mul_f32 v47, v47, v38
  v_cvt_pk_bf16_f32 v24, v40, v41
  v_cvt_pk_bf16_f32 v25, v42, v43
  v_cvt_pk_bf16_f32 v26, v44, v45
  v_cvt_pk_bf16_f32 v27, v46, v47
  v_lshlrev_b32 v28, 16, v24
  v_and_b32 v29, s69, v24
  v_lshlrev_b32 v30, 16, v25
  v_and_b32 v31, s69, v25
  v_lshlrev_b32 v32, 16, v26
  v_and_b32 v33, s69, v26
  v_lshlrev_b32 v34, 16, v27
  v_and_b32 v35, s69, v27
  v_lshlrev_b32 v5, 5, v1
  s_lshl_b32 s67, s60, 11
  v_add_u32 v5, s67, v5
  ds_write_b128 v5, v[28:31] offset:0
  buffer_load_dwordx4 v[100:103], v2, s[28:31], s88 offen offset:1024 nt
  ds_write_b128 v5, v[32:35] offset:16
  v_lshrrev_b32 v5, 1, v1
  v_lshlrev_b32 v5, 2, v5
  s_lshl_b32 s67, s74, 8
  v_add_u32 v5, s67, v5
  v_add_u32 v6, 128, v5
  s_waitcnt lgkmcnt(0)
  s_barrier
  ds_read2st64_b32 v[24:25], v5 offset0:0 offset1:8
  ds_read2st64_b32 v[26:27], v5 offset0:16 offset1:24
  ds_read2st64_b32 v[28:29], v5 offset0:32 offset1:40
  ds_read2st64_b32 v[30:31], v5 offset0:48 offset1:56
  ds_read2st64_b32 v[32:33], v6 offset0:0 offset1:8
  ds_read2st64_b32 v[34:35], v6 offset0:16 offset1:24
  ds_read2st64_b32 v[36:37], v6 offset0:32 offset1:40
  ds_read2st64_b32 v[38:39], v6 offset0:48 offset1:56
  s_waitcnt vmcnt(10)
  v_lshlrev_b32 v40, 16, v56
  v_and_b32 v41, s69, v56
  v_lshlrev_b32 v42, 16, v57
  v_and_b32 v43, s69, v57
  v_lshlrev_b32 v44, 16, v58
  v_and_b32 v45, s69, v58
  v_lshlrev_b32 v46, 16, v59
  v_and_b32 v47, s69, v59
  v_lshlrev_b32 v48, 16, v60
  v_and_b32 v49, s69, v60
  v_lshlrev_b32 v50, 16, v61
  v_and_b32 v51, s69, v61
  v_lshlrev_b32 v52, 16, v62
  v_and_b32 v53, s69, v62
  v_lshlrev_b32 v54, 16, v63
  v_and_b32 v55, s69, v63
  s_waitcnt lgkmcnt(4)
  v_pk_mul_f32 v[192:193], v[40:41], v[24:25] op_sel_hi:[1,0]
  v_pk_mul_f32 v[194:195], v[42:43], v[24:25] op_sel_hi:[1,0]
  v_pk_mul_f32 v[196:197], v[44:45], v[24:25] op_sel_hi:[1,0]
  v_pk_mul_f32 v[198:199], v[46:47], v[24:25] op_sel_hi:[1,0]
  v_pk_mul_f32 v[200:201], v[40:41], v[24:25] op_sel:[0,1] op_sel_hi:[1,1]
  v_pk_mul_f32 v[202:203], v[42:43], v[24:25] op_sel:[0,1] op_sel_hi:[1,1]
  v_pk_mul_f32 v[204:205], v[44:45], v[24:25] op_sel:[0,1] op_sel_hi:[1,1]
  v_pk_mul_f32 v[206:207], v[46:47], v[24:25] op_sel:[0,1] op_sel_hi:[1,1]
  v_pk_mul_f32 v[208:209], v[40:41], v[26:27] op_sel_hi:[1,0]
  v_pk_mul_f32 v[210:211], v[42:43], v[26:27] op_sel_hi:[1,0]
  v_pk_mul_f32 v[212:213], v[44:45], v[26:27] op_sel_hi:[1,0]
  v_pk_mul_f32 v[214:215], v[46:47], v[26:27] op_sel_hi:[1,0]
  v_pk_mul_f32 v[216:217], v[40:41], v[26:27] op_sel:[0,1] op_sel_hi:[1,1]
  buffer_load_dwordx4 v[104:107], v2, s[28:31], s88 offen offset:2048 nt
  v_pk_mul_f32 v[218:219], v[42:43], v[26:27] op_sel:[0,1] op_sel_hi:[1,1]
  v_pk_mul_f32 v[220:221], v[44:45], v[26:27] op_sel:[0,1] op_sel_hi:[1,1]
  v_pk_mul_f32 v[222:223], v[46:47], v[26:27] op_sel:[0,1] op_sel_hi:[1,1]
  v_pk_mul_f32 v[224:225], v[40:41], v[28:29] op_sel_hi:[1,0]
  v_pk_mul_f32 v[226:227], v[42:43], v[28:29] op_sel_hi:[1,0]
  v_pk_mul_f32 v[228:229], v[44:45], v[28:29] op_sel_hi:[1,0]
  v_pk_mul_f32 v[230:231], v[46:47], v[28:29] op_sel_hi:[1,0]
  v_pk_mul_f32 v[232:233], v[40:41], v[28:29] op_sel:[0,1] op_sel_hi:[1,1]
  v_pk_mul_f32 v[234:235], v[42:43], v[28:29] op_sel:[0,1] op_sel_hi:[1,1]
  v_pk_mul_f32 v[236:237], v[44:45], v[28:29] op_sel:[0,1] op_sel_hi:[1,1]
  v_pk_mul_f32 v[238:239], v[46:47], v[28:29] op_sel:[0,1] op_sel_hi:[1,1]
  v_pk_mul_f32 v[240:241], v[40:41], v[30:31] op_sel_hi:[1,0]
  v_pk_mul_f32 v[242:243], v[42:43], v[30:31] op_sel_hi:[1,0]
  v_pk_mul_f32 v[244:245], v[44:45], v[30:31] op_sel_hi:[1,0]
  v_pk_mul_f32 v[246:247], v[46:47], v[30:31] op_sel_hi:[1,0]
  v_pk_mul_f32 v[248:249], v[40:41], v[30:31] op_sel:[0,1] op_sel_hi:[1,1]
  v_pk_mul_f32 v[250:251], v[42:43], v[30:31] op_sel:[0,1] op_sel_hi:[1,1]
  v_pk_mul_f32 v[252:253], v[44:45], v[30:31] op_sel:[0,1] op_sel_hi:[1,1]
  v_pk_mul_f32 v[254:255], v[46:47], v[30:31] op_sel:[0,1] op_sel_hi:[1,1]
  s_waitcnt lgkmcnt(0)
  v_pk_fma_f32 v[192:193], v[48:49], v[32:33], v[192:193] op_sel_hi:[1,0,1]
  v_pk_fma_f32 v[194:195], v[50:51], v[32:33], v[194:195] op_sel_hi:[1,0,1]
  v_pk_fma_f32 v[196:197], v[52:53], v[32:33], v[196:197] op_sel_hi:[1,0,1]
  v_pk_fma_f32 v[198:199], v[54:55], v[32:33], v[198:199] op_sel_hi:[1,0,1]
  v_pk_fma_f32 v[200:201], v[48:49], v[32:33], v[200:201] op_sel:[0,1,0] op_sel_hi:[1,1,1]
  v_pk_fma_f32 v[202:203], v[50:51], v[32:33], v[202:203] op_sel:[0,1,0] op_sel_hi:[1,1,1]
  v_pk_fma_f32 v[204:205], v[52:53], v[32:33], v[204:205] op_sel:[0,1,0] op_sel_hi:[1,1,1]
  v_pk_fma_f32 v[206:207], v[54:55], v[32:33], v[206:207] op_sel:[0,1,0] op_sel_hi:[1,1,1]
  v_pk_fma_f32 v[208:209], v[48:49], v[34:35], v[208:209] op_sel_hi:[1,0,1]
  v_pk_fma_f32 v[210:211], v[50:51], v[34:35], v[210:211] op_sel_hi:[1,0,1]
  buffer_load_dwordx4 v[108:111], v2, s[28:31], s88 offen offset:3072 nt
  v_pk_fma_f32 v[212:213], v[52:53], v[34:35], v[212:213] op_sel_hi:[1,0,1]
  v_pk_fma_f32 v[214:215], v[54:55], v[34:35], v[214:215] op_sel_hi:[1,0,1]
  v_pk_fma_f32 v[216:217], v[48:49], v[34:35], v[216:217] op_sel:[0,1,0] op_sel_hi:[1,1,1]
  v_pk_fma_f32 v[218:219], v[50:51], v[34:35], v[218:219] op_sel:[0,1,0] op_sel_hi:[1,1,1]
  v_pk_fma_f32 v[220:221], v[52:53], v[34:35], v[220:221] op_sel:[0,1,0] op_sel_hi:[1,1,1]
  v_pk_fma_f32 v[222:223], v[54:55], v[34:35], v[222:223] op_sel:[0,1,0] op_sel_hi:[1,1,1]
  v_pk_fma_f32 v[224:225], v[48:49], v[36:37], v[224:225] op_sel_hi:[1,0,1]
  v_pk_fma_f32 v[226:227], v[50:51], v[36:37], v[226:227] op_sel_hi:[1,0,1]
  v_pk_fma_f32 v[228:229], v[52:53], v[36:37], v[228:229] op_sel_hi:[1,0,1]
  v_pk_fma_f32 v[230:231], v[54:55], v[36:37], v[230:231] op_sel_hi:[1,0,1]
  v_pk_fma_f32 v[232:233], v[48:49], v[36:37], v[232:233] op_sel:[0,1,0] op_sel_hi:[1,1,1]
  v_pk_fma_f32 v[234:235], v[50:51], v[36:37], v[234:235] op_sel:[0,1,0] op_sel_hi:[1,1,1]
  v_pk_fma_f32 v[236:237], v[52:53], v[36:37], v[236:237] op_sel:[0,1,0] op_sel_hi:[1,1,1]
  v_pk_fma_f32 v[238:239], v[54:55], v[36:37], v[238:239] op_sel:[0,1,0] op_sel_hi:[1,1,1]
  v_pk_fma_f32 v[240:241], v[48:49], v[38:39], v[240:241] op_sel_hi:[1,0,1]
  v_pk_fma_f32 v[242:243], v[50:51], v[38:39], v[242:243] op_sel_hi:[1,0,1]
  v_pk_fma_f32 v[244:245], v[52:53], v[38:39], v[244:245] op_sel_hi:[1,0,1]
  v_pk_fma_f32 v[246:247], v[54:55], v[38:39], v[246:247] op_sel_hi:[1,0,1]
  v_pk_fma_f32 v[248:249], v[48:49], v[38:39], v[248:249] op_sel:[0,1,0] op_sel_hi:[1,1,1]
  v_pk_fma_f32 v[250:251], v[50:51], v[38:39], v[250:251] op_sel:[0,1,0] op_sel_hi:[1,1,1]
  v_pk_fma_f32 v[252:253], v[52:53], v[38:39], v[252:253] op_sel:[0,1,0] op_sel_hi:[1,1,1]
  v_pk_fma_f32 v[254:255], v[54:55], v[38:39], v[254:255] op_sel:[0,1,0] op_sel_hi:[1,1,1]
  v_permlane32_swap_b32 v192, v224
  v_permlane32_swap_b32 v193, v225
  v_permlane32_swap_b32 v194, v226
  v_permlane32_swap_b32 v195, v227
  v_permlane32_swap_b32 v196, v228
  v_permlane32_swap_b32 v197, v229
  v_permlane32_swap_b32 v198, v230
  buffer_load_dwordx4 v[112:115], v2, s[32:35], s88 offen offset:0 nt
  v_permlane32_swap_b32 v199, v231
  v_permlane32_swap_b32 v200, v232
  v_permlane32_swap_b32 v201, v233
  v_permlane32_swap_b32 v202, v234
  v_permlane32_swap_b32 v203, v235
  v_permlane32_swap_b32 v204, v236
  v_permlane32_swap_b32 v205, v237
  v_permlane32_swap_b32 v206, v238
  v_permlane32_swap_b32 v207, v239
  v_permlane32_swap_b32 v208, v240
  v_permlane32_swap_b32 v209, v241
  v_permlane32_swap_b32 v210, v242
  v_permlane32_swap_b32 v211, v243
  v_permlane32_swap_b32 v212, v244
  v_permlane32_swap_b32 v213, v245
  v_permlane32_swap_b32 v214, v246
  v_permlane32_swap_b32 v215, v247
  v_permlane32_swap_b32 v216, v248
  v_permlane32_swap_b32 v217, v249
  v_permlane32_swap_b32 v218, v250
  v_permlane32_swap_b32 v219, v251
  v_permlane32_swap_b32 v220, v252
  v_permlane32_swap_b32 v221, v253
  v_permlane32_swap_b32 v222, v254
  v_permlane32_swap_b32 v223, v255
  v_pk_add_f32 v[192:193], v[192:193], v[224:225]
  v_pk_add_f32 v[194:195], v[194:195], v[226:227]
  v_pk_add_f32 v[196:197], v[196:197], v[228:229]
  v_pk_add_f32 v[198:199], v[198:199], v[230:231]
  v_pk_add_f32 v[200:201], v[200:201], v[232:233]
  buffer_load_dwordx4 v[116:119], v2, s[32:35], s88 offen offset:1024 nt
  v_pk_add_f32 v[202:203], v[202:203], v[234:235]
  v_pk_add_f32 v[204:205], v[204:205], v[236:237]
  v_pk_add_f32 v[206:207], v[206:207], v[238:239]
  v_pk_add_f32 v[208:209], v[208:209], v[240:241]
  v_pk_add_f32 v[210:211], v[210:211], v[242:243]
  v_pk_add_f32 v[212:213], v[212:213], v[244:245]
  v_pk_add_f32 v[214:215], v[214:215], v[246:247]
  v_pk_add_f32 v[216:217], v[216:217], v[248:249]
  v_pk_add_f32 v[218:219], v[218:219], v[250:251]
  v_pk_add_f32 v[220:221], v[220:221], v[252:253]
  v_pk_add_f32 v[222:223], v[222:223], v[254:255]
  v_permlane16_swap_b32 v192, v208
  v_permlane16_swap_b32 v193, v209
  v_permlane16_swap_b32 v194, v210
  v_permlane16_swap_b32 v195, v211
  v_permlane16_swap_b32 v196, v212
  v_permlane16_swap_b32 v197, v213
  v_permlane16_swap_b32 v198, v214
  v_permlane16_swap_b32 v199, v215
  v_permlane16_swap_b32 v200, v216
  v_permlane16_swap_b32 v201, v217
  v_permlane16_swap_b32 v202, v218
  v_permlane16_swap_b32 v203, v219
  v_permlane16_swap_b32 v204, v220
  v_permlane16_swap_b32 v205, v221
  v_permlane16_swap_b32 v206, v222
  v_permlane16_swap_b32 v207, v223
  v_pk_add_f32 v[192:193], v[192:193], v[208:209]
  v_pk_add_f32 v[194:195], v[194:195], v[210:211]
  v_pk_add_f32 v[196:197], v[196:197], v[212:213]
  buffer_load_dwordx4 v[120:123], v2, s[32:35], s88 offen offset:2048 nt
  v_pk_add_f32 v[198:199], v[198:199], v[214:215]
  v_pk_add_f32 v[200:201], v[200:201], v[216:217]
  v_pk_add_f32 v[202:203], v[202:203], v[218:219]
  v_pk_add_f32 v[204:205], v[204:205], v[220:221]
  v_pk_add_f32 v[206:207], v[206:207], v[222:223]
  v_add_f32_dpp v224, v192, v192 row_ror:8 row_mask:0xf bank_mask:0x3
  v_add_f32_dpp v225, v193, v193 row_ror:8 row_mask:0xf bank_mask:0x3
  v_add_f32_dpp v226, v194, v194 row_ror:8 row_mask:0xf bank_mask:0x3
  v_add_f32_dpp v227, v195, v195 row_ror:8 row_mask:0xf bank_mask:0x3
  v_add_f32_dpp v228, v196, v196 row_ror:8 row_mask:0xf bank_mask:0x3
  v_add_f32_dpp v229, v197, v197 row_ror:8 row_mask:0xf bank_mask:0x3
  v_add_f32_dpp v230, v198, v198 row_ror:8 row_mask:0xf bank_mask:0x3
  v_add_f32_dpp v231, v199, v199 row_ror:8 row_mask:0xf bank_mask:0x3
  v_add_f32_dpp v224, v200, v200 row_ror:8 row_mask:0xf bank_mask:0xc
  v_add_f32_dpp v225, v201, v201 row_ror:8 row_mask:0xf bank_mask:0xc
  v_add_f32_dpp v226, v202, v202 row_ror:8 row_mask:0xf bank_mask:0xc
  v_add_f32_dpp v227, v203, v203 row_ror:8 row_mask:0xf bank_mask:0xc
  v_add_f32_dpp v228, v204, v204 row_ror:8 row_mask:0xf bank_mask:0xc
  v_add_f32_dpp v229, v205, v205 row_ror:8 row_mask:0xf bank_mask:0xc
  v_add_f32_dpp v230, v206, v206 row_ror:8 row_mask:0xf bank_mask:0xc
  v_add_f32_dpp v231, v207, v207 row_ror:8 row_mask:0xf bank_mask:0xc
  v_add_f32_dpp v240, v224, v224 row_shl:4 row_mask:0xf bank_mask:0x5
  v_add_f32_dpp v241, v225, v225 row_shl:4 row_mask:0xf bank_mask:0x5
  v_add_f32_dpp v242, v226, v226 row_shl:4 row_mask:0xf bank_mask:0x5
  v_add_f32_dpp v243, v227, v227 row_shl:4 row_mask:0xf bank_mask:0x5
  v_add_f32_dpp v240, v228, v228 row_shr:4 row_mask:0xf bank_mask:0xa
  v_add_f32_dpp v241, v229, v229 row_shr:4 row_mask:0xf bank_mask:0xa
  v_add_f32_dpp v242, v230, v230 row_shr:4 row_mask:0xf bank_mask:0xa
  v_add_f32_dpp v243, v231, v231 row_shr:4 row_mask:0xf bank_mask:0xa
  v_lshrrev_b32 v5, 3, v1
  v_lshlrev_b32 v5, 6, v5
  v_and_b32 v6, 1, v1
  v_lshl_add_u32 v5, v6, 5, v5
  v_and_b32 v6, 4, v1
  v_lshl_add_u32 v5, v6, 2, v5
  v_add_f32_dpp v240, v240, v240 quad_perm:[2,3,0,1] row_mask:0xf bank_mask:0xf
  v_add_f32_dpp v241, v241, v241 quad_perm:[2,3,0,1] row_mask:0xf bank_mask:0xf
  v_add_f32_dpp v242, v242, v242 quad_perm:[2,3,0,1] row_mask:0xf bank_mask:0xf
  v_add_f32_dpp v243, v243, v243 quad_perm:[2,3,0,1] row_mask:0xf bank_mask:0xf
  s_lshl_b32 s67, s74, 9
  v_add_u32 v5, s67, v5
  ds_write_b128 v5, v[240:243] offset:16384
  buffer_load_dwordx4 v[124:127], v2, s[32:35], s88 offen offset:3072 nt
  v_and_b32 v39, 31, v1
  v_lshlrev_b32 v39, 5, v39
  s_lshl_b32 s71, s3, 10
  s_add_u32 s71, s71, 1703936
  s_waitcnt lgkmcnt(0)
  s_barrier
  s_cmp_lg_u32 s60, 0
  s_cbranch_scc1 L_nopub
  v_lshlrev_b32 v5, 5, v1
  s_mov_b64 exec, 0xffff
  ds_read_b128 v[192:195], v5 offset:16384
  ds_read_b128 v[196:199], v5 offset:16400
  ds_read_b128 v[200:203], v5 offset:16896
  ds_read_b128 v[204:207], v5 offset:16912
  ds_read_b128 v[208:211], v5 offset:17408
  ds_read_b128 v[212:215], v5 offset:17424
  ds_read_b128 v[216:219], v5 offset:17920
  ds_read_b128 v[220:223], v5 offset:17936
  ds_read_b128 v[224:227], v5 offset:18432
  ds_read_b128 v[228:231], v5 offset:18448
  ds_read_b128 v[232:235], v5 offset:18944
  ds_read_b128 v[236:239], v5 offset:18960
  ds_read_b128 v[240:243], v5 offset:19456
  ds_read_b128 v[244:247], v5 offset:19472
  v_lshrrev_b32 v6, 1, v1
  v_lshlrev_b32 v6, 14, v6
  v_and_b32 v5, 1, v1
  v_lshl_add_u32 v6, v5, 5, v6
  s_lshl_b32 s67, s94, 6
  s_add_u32 s67, s67, 1703936
  v_readfirstlane_b32 s68, v20
  s_cmp_eq_u32 s68, 0
  s_cselect_b32 s68, s100, s68
  s_and_b32 s72, s68, 0xffff
  s_lshr_b32 s73, s68, 16
  v_mov_b32 v40, s72
  v_mov_b32 v41, s73
  s_waitcnt lgkmcnt(10)
  v_pk_add_f32 v[192:193], v[192:193], v[200:201]
  v_pk_add_f32 v[194:195], v[194:195], v[202:203]
  v_pk_add_f32 v[196:197], v[196:197], v[204:205]
  v_pk_add_f32 v[198:199], v[198:199], v[206:207]
  s_waitcnt lgkmcnt(8)
  v_pk_add_f32 v[192:193], v[192:193], v[208:209]
  v_pk_add_f32 v[194:195], v[194:195], v[210:211]
  v_pk_add_f32 v[196:197], v[196:197], v[212:213]
  v_pk_add_f32 v[198:199], v[198:199], v[214:215]
  s_waitcnt lgkmcnt(6)
  v_pk_add_f32 v[192:193], v[192:193], v[216:217]
  v_pk_add_f32 v[194:195], v[194:195], v[218:219]
  v_pk_add_f32 v[196:197], v[196:197], v[220:221]
  v_pk_add_f32 v[198:199], v[198:199], v[222:223]
  s_waitcnt lgkmcnt(4)
  v_pk_add_f32 v[192:193], v[192:193], v[224:225]
  v_pk_add_f32 v[194:195], v[194:195], v[226:227]
  v_pk_add_f32 v[196:197], v[196:197], v[228:229]
  v_pk_add_f32 v[198:199], v[198:199], v[230:231]
  s_waitcnt lgkmcnt(2)
  v_pk_add_f32 v[192:193], v[192:193], v[232:233]
  v_pk_add_f32 v[194:195], v[194:195], v[234:235]
  v_pk_add_f32 v[196:197], v[196:197], v[236:237]
  v_pk_add_f32 v[198:199], v[198:199], v[238:239]
  s_waitcnt lgkmcnt(0)
  v_pk_add_f32 v[192:193], v[192:193], v[240:241]
  v_pk_add_f32 v[194:195], v[194:195], v[242:243]
  v_pk_add_f32 v[196:197], v[196:197], v[244:245]
  v_pk_add_f32 v[198:199], v[198:199], v[246:247]
  v_cvt_pk_bf16_f32 v192, v192, v192
  v_cvt_pk_bf16_f32 v193, v193, v193
  v_cvt_pk_bf16_f32 v194, v194, v194
  v_cvt_pk_bf16_f32 v195, v195, v195
  v_cvt_pk_bf16_f32 v196, v196, v196
  v_cvt_pk_bf16_f32 v197, v197, v197
  v_cvt_pk_bf16_f32 v198, v198, v198
  v_cvt_pk_bf16_f32 v199, v199, v199
  v_and_or_b32 v248, v192, s69, v40
  v_and_or_b32 v249, v193, s69, v41
  v_and_or_b32 v250, v194, s69, v40
  v_and_or_b32 v251, v195, s69, v41
  v_and_or_b32 v252, v196, s69, v40
  v_and_or_b32 v253, v197, s69, v41
  v_and_or_b32 v254, v198, s69, v40
  v_and_or_b32 v255, v199, s69, v41
  buffer_store_dwordx4 v[248:251], v6, s[56:59], s67 offen sc1
  buffer_store_dwordx4 v[252:255], v6, s[56:59], s67 offen offset:16 sc1
  s_mov_b64 exec, -1
  s_mov_b32 s65, 0
L_qpoll:
  buffer_load_dwordx4 v[40:43], v39, s[56:59], s71 offen sc1
  buffer_load_dwordx4 v[44:47], v39, s[56:59], s71 offen offset:16 sc1
  s_add_u32 s65, s65, 1
  s_waitcnt vmcnt(0)
  v_xor_b32 v24, s72, v40
  v_xor_b32 v25, s73, v41
  v_xor_b32 v26, s72, v42
  v_xor_b32 v27, s73, v43
  v_xor_b32 v28, s72, v44
  v_xor_b32 v29, s73, v45
  v_xor_b32 v30, s72, v46
  v_xor_b32 v31, s73, v47
  v_or3_b32 v24, v24, v25, v26
  v_or3_b32 v27, v27, v28, v29
  v_or3_b32 v24, v24, v30, v31
  v_or_b32 v24, v24, v27
  v_and_b32 v24, 0xffff, v24
  v_cmp_ne_u32 vcc, 0, v24
  s_cbranch_vccz L_qgot
  s_cmp_lt_u32 s65, 2097152
  s_cbranch_scc1 L_qpoll
L_qgot:
  s_mov_b32 s67, 0x07060302
  v_perm_b32 v24, v41, v40, s67
  v_perm_b32 v25, v43, v42, s67
  v_perm_b32 v26, v45, v44, s67
  v_perm_b32 v27, v47, v46, s67
  v_lshrrev_b32 v28, 1, v39
  ds_write_b128 v28, v[24:27] offset:47360
  v_mov_b32 v29, 47300
  v_mov_b32 v30, 1
  s_waitcnt lgkmcnt(0)
  ds_write_b32 v29, v30
L_nopub:
  s_cmp_lg_u32 s60, 1
  s_cbranch_scc1 L_noclr
  v_mov_b32 v48, -1
  v_mov_b32 v49, -1
  v_mov_b32 v50, -1
  v_mov_b32 v51, -1
  buffer_store_dwordx4 v[48:51], v2, s[56:59], s95 offen offset:0 sc1
  buffer_store_dwordx4 v[48:51], v2, s[56:59], s95 offen offset:1024 sc1
  buffer_store_dwordx4 v[48:51], v2, s[56:59], s95 offen offset:2048 sc1
  buffer_store_dwordx4 v[48:51], v2, s[56:59], s95 offen offset:3072 sc1
  s_cmp_lg_u32 s63, 0
  s_cbranch_scc1 L_noclr
  s_lshl_b32 s67, s3, 8
  s_add_u32 s67, s67, 1572864
  s_mov_b64 exec, 1
  buffer_store_dword v12, v12, s[56:59], s67 offen sc1
  s_mov_b64 exec, -1
L_noclr:
  buffer_load_dwordx4 v[128:131], v2, s[28:31], s89 offen offset:0 nt
  buffer_load_dwordx4 v[132:135], v2, s[28:31], s89 offen offset:1024 nt
  buffer_load_dwordx4 v[136:139], v2, s[28:31], s89 offen offset:2048 nt
  buffer_load_dwordx4 v[140:143], v2, s[28:31], s89 offen offset:3072 nt
  buffer_load_dwordx4 v[144:147], v2, s[32:35], s89 offen offset:0 nt
  buffer_load_dwordx4 v[148:151], v2, s[32:35], s89 offen offset:1024 nt
  buffer_load_dwordx4 v[152:155], v2, s[32:35], s89 offen offset:2048 nt
  buffer_load_dwordx4 v[156:159], v2, s[32:35], s89 offen offset:3072 nt
  buffer_load_dwordx4 v[160:163], v2, s[28:31], s90 offen offset:0 nt
  buffer_load_dwordx4 v[164:167], v2, s[28:31], s90 offen offset:1024 nt
  buffer_load_dwordx4 v[168:171], v2, s[28:31], s90 offen offset:2048 nt
  buffer_load_dwordx4 v[172:175], v2, s[28:31], s90 offen offset:3072 nt
  buffer_load_dwordx4 v[176:179], v2, s[32:35], s90 offen offset:0 nt
  buffer_load_dwordx4 v[180:183], v2, s[32:35], s90 offen offset:1024 nt
  buffer_load_dwordx4 v[184:187], v2, s[32:35], s90 offen offset:2048 nt
  buffer_load_dwordx4 v[188:191], v2, s[32:35], s90 offen offset:3072 nt
  v_lshrrev_b32 v5, 3, v1
  v_and_b32 v6, 7, v1
  v_mul_u32_u24 v4, 3584, v5
  v_lshl_add_u32 v4, v6, 4, v4
  s_and_b32 s67, s60, 3
  s_mul_i32 s87, s67, 401408
  s_lshl_b32 s68, s64, 7
  s_add_u32 s87, s87, s68
  s_cmp_lt_u32 s64, 28
  s_cselect_b32 s42, s42, 0
  s_cselect_b32 s54, s54, 0
  s_mov_b32 s65, 0
  v_mov_b32 v5, 47300
  v_lshrrev_b32 v6, 1, v39
L_qwait:
  ds_read_b32 v24, v5
  ds_read_b128 v[8:11], v6 offset:47360
  s_waitcnt lgkmcnt(0)
  v_readfirstlane_b32 s67, v24
  s_cmp_lg_u32 s67, 0
  s_cbranch_scc1 L_qok
  s_sleep 1
  s_add_u32 s65, s65, 1
  s_cmp_lt_u32 s65, 2097152
  s_cbranch_scc1 L_qwait
L_qok:
  v_and_b32 v6, 31, v1
  v_lshlrev_b32 v6, 5, v6
  v_lshrrev_b32 v5, 5, v1
  v_lshl_add_u32 v6, v5, 4, v6
  v_mov_b32 v20, 0xf149f2ca
  v_mov_b32 v21, 0
  s_mov_b32 s65, 0
  s_mov_b32 s93, 0x05040100
  s_mov_b32 s94, 0x07060302
  s_add_u32 s66, s66, 131072
  s_add_u32 s88, s66, 32768
  s_lshl_b32 s90, s3, 8
  s_add_u32 s90, s90, 1572864
  .p2align 6
L_loop:
  s_waitcnt vmcnt(12)
  v_dot2_f32_bf16 v22, v64, v8, 0
  v_dot2_f32_bf16 v23, v68, v8, 0
  v_dot2_f32_bf16 v24, v72, v8, 0
  v_dot2_f32_bf16 v25, v76, v8, 0
  v_dot2c_f32_bf16 v22, v65, v9
  v_dot2c_f32_bf16 v23, v69, v9
  v_dot2c_f32_bf16 v24, v73, v9
  v_dot2c_f32_bf16 v25, v77, v9
  v_dot2c_f32_bf16 v22, v66, v10
  v_dot2c_f32_bf16 v23, v70, v10
  v_dot2c_f32_bf16 v24, v74, v10
  v_dot2c_f32_bf16 v25, v78, v10
  v_dot2c_f32_bf16 v22, v67, v11
  v_dot2c_f32_bf16 v23, v71, v11
  v_dot2c_f32_bf16 v24, v75, v11
  v_dot2c_f32_bf16 v25, v79, v11
  buffer_load_dwordx4 v[64:67], v2, s[28:31], s66 offen offset:0 nt
  buffer_load_dwordx4 v[68:71], v2, s[28:31], s66 offen offset:1024 nt
  buffer_load_dwordx4 v[72:75], v2, s[28:31], s66 offen offset:2048 nt
  buffer_load_dwordx4 v[76:79], v2, s[28:31], s66 offen offset:3072 nt
  v_permlane16_swap_b32 v22, v23
  v_permlane16_swap_b32 v24, v25
  s_nop 0
  v_add_f32 v22, v22, v23
  v_add_f32 v24, v24, v25
  s_nop 0
  v_add_f32_dpp v26, v22, v22 row_ror:8 row_mask:0xf bank_mask:0x3
  v_add_f32_dpp v26, v24, v24 row_ror:8 row_mask:0xf bank_mask:0xc
  s_nop 1
  v_add_f32_dpp v26, v26, v26 quad_perm:[1,0,3,2] row_mask:0xf bank_mask:0xf
  s_nop 1
  v_add_f32_dpp v26, v26, v26 quad_perm:[2,3,0,1] row_mask:0xf bank_mask:0xf
  s_nop 1
  v_add_f32_dpp v26, v26, v26 row_half_mirror row_mask:0xf bank_mask:0xf
  v_cvt_pk_bf16_f32 v26, v26, v26
  v_and_b32 v26, s69, v26
  v_mul_f32 v26, 0x3db8aa3b, v26
  v_cmp_gt_f32 vcc, v26, v20
  s_cbranch_vccnz L_rescA
L_backA:
  v_sub_f32 v27, v26, v20
  v_exp_f32 v27, v27
  s_nop 0
  v_add_f32 v21, v21, v27
  v_mov_b32 v28, v27
  s_nop 1
  v_permlane16_swap_b32 v27, v28
  s_nop 1
  v_mov_b32_dpp v30, v27 row_newbcast:0 row_mask:0xf bank_mask:0xf
  v_mov_b32_dpp v31, v28 row_newbcast:0 row_mask:0xf bank_mask:0xf
  v_mov_b32_dpp v32, v27 row_newbcast:8 row_mask:0xf bank_mask:0xf
  v_mov_b32_dpp v33, v28 row_newbcast:8 row_mask:0xf bank_mask:0xf
  s_waitcnt vmcnt(12)
  v_lshlrev_b32 v34, 16, v80
  v_and_b32 v35, s69, v80
  v_lshlrev_b32 v36, 16, v81
  v_and_b32 v37, s69, v81
  v_lshlrev_b32 v38, 16, v82
  v_and_b32 v39, s69, v82
  v_lshlrev_b32 v40, 16, v83
  v_and_b32 v41, s69, v83
  v_pk_fma_f32 v[12:13], v[34:35], v[30:31], v[12:13] op_sel_hi:[1,0,1]
  v_pk_fma_f32 v[14:15], v[36:37], v[30:31], v[14:15] op_sel_hi:[1,0,1]
  v_pk_fma_f32 v[16:17], v[38:39], v[30:31], v[16:17] op_sel_hi:[1,0,1]
  v_pk_fma_f32 v[18:19], v[40:41], v[30:31], v[18:19] op_sel_hi:[1,0,1]
  v_lshlrev_b32 v34, 16, v84
  v_and_b32 v35, s69, v84
  v_lshlrev_b32 v36, 16, v85
  v_and_b32 v37, s69, v85
  v_lshlrev_b32 v38, 16, v86
  v_and_b32 v39, s69, v86
  v_lshlrev_b32 v40, 16, v87
  v_and_b32 v41, s69, v87
  v_pk_fma_f32 v[12:13], v[34:35], v[30:31], v[12:13] op_sel:[0,1,0] op_sel_hi:[1,1,1]
  v_pk_fma_f32 v[14:15], v[36:37], v[30:31], v[14:15] op_sel:[0,1,0] op_sel_hi:[1,1,1]
  v_pk_fma_f32 v[16:17], v[38:39], v[30:31], v[16:17] op_sel:[0,1,0] op_sel_hi:[1,1,1]
  v_pk_fma_f32 v[18:19], v[40:41], v[30:31], v[18:19] op_sel:[0,1,0] op_sel_hi:[1,1,1]
  v_lshlrev_b32 v34, 16, v88
  v_and_b32 v35, s69, v88
  v_lshlrev_b32 v36, 16, v89
  v_and_b32 v37, s69, v89
  v_lshlrev_b32 v38, 16, v90
  v_and_b32 v39, s69, v90
  v_lshlrev_b32 v40, 16, v91
  v_and_b32 v41, s69, v91
  v_pk_fma_f32 v[12:13], v[34:35], v[32:33], v[12:13] op_sel_hi:[1,0,1]
  v_pk_fma_f32 v[14:15], v[36:37], v[32:33], v[14:15] op_sel_hi:[1,0,1]
  v_pk_fma_f32 v[16:17], v[38:39], v[32:33], v[16:17] op_sel_hi:[1,0,1]
  v_pk_fma_f32 v[18:19], v[40:41], v[32:33], v[18:19] op_sel_hi:[1,0,1]
  v_lshlrev_b32 v34, 16, v92
  v_and_b32 v35, s69, v92
  v_lshlrev_b32 v36, 16, v93
  v_and_b32 v37, s69, v93
  v_lshlrev_b32 v38, 16, v94
  v_and_b32 v39, s69, v94
  v_lshlrev_b32 v40, 16, v95
  v_and_b32 v41, s69, v95
  v_pk_fma_f32 v[12:13], v[34:35], v[32:33], v[12:13] op_sel:[0,1,0] op_sel_hi:[1,1,1]
  v_pk_fma_f32 v[14:15], v[36:37], v[32:33], v[14:15] op_sel:[0,1,0] op_sel_hi:[1,1,1]
  v_pk_fma_f32 v[16:17], v[38:39], v[32:33], v[16:17] op_sel:[0,1,0] op_sel_hi:[1,1,1]
  v_pk_fma_f32 v[18:19], v[40:41], v[32:33], v[18:19] op_sel:[0,1,0] op_sel_hi:[1,1,1]
  buffer_load_dwordx4 v[80:83], v2, s[32:35], s66 offen offset:0 nt
  buffer_load_dwordx4 v[84:87], v2, s[32:35], s66 offen offset:1024 nt
  buffer_load_dwordx4 v[88:91], v2, s[32:35], s66 offen offset:2048 nt
  buffer_load_dwordx4 v[92:95], v2, s[32:35], s66 offen offset:3072 nt
  s_waitcnt vmcnt(12)
  v_dot2_f32_bf16 v22, v96, v8, 0
  v_dot2_f32_bf16 v23, v100, v8, 0
  v_dot2_f32_bf16 v24, v104, v8, 0
  v_dot2_f32_bf16 v25, v108, v8, 0
  v_dot2c_f32_bf16 v22, v97, v9
  v_dot2c_f32_bf16 v23, v101, v9
  v_dot2c_f32_bf16 v24, v105, v9
  v_dot2c_f32_bf16 v25, v109, v9
  v_dot2c_f32_bf16 v22, v98, v10
  v_dot2c_f32_bf16 v23, v102, v10
  v_dot2c_f32_bf16 v24, v106, v10
  v_dot2c_f32_bf16 v25, v110, v10
  v_dot2c_f32_bf16 v22, v99, v11
  v_dot2c_f32_bf16 v23, v103, v11
  v_dot2c_f32_bf16 v24, v107, v11
  v_dot2c_f32_bf16 v25, v111, v11
  buffer_load_dwordx4 v[96:99], v2, s[28:31], s88 offen offset:0 nt
  buffer_load_dwordx4 v[100:103], v2, s[28:31], s88 offen offset:1024 nt
  buffer_load_dwordx4 v[104:107], v2, s[28:31], s88 offen offset:2048 nt
  buffer_load_dwordx4 v[108:111], v2, s[28:31], s88 offen offset:3072 nt
  v_permlane16_swap_b32 v22, v23
  v_permlane16_swap_b32 v24, v25
  s_nop 0
  v_add_f32 v22, v22, v23
  v_add_f32 v24, v24, v25
  s_nop 0
  v_add_f32_dpp v26, v22, v22 row_ror:8 row_mask:0xf bank_mask:0x3
  v_add_f32_dpp v26, v24, v24 row_ror:8 row_mask:0xf bank_mask:0xc
  s_nop 1
  v_add_f32_dpp v26, v26, v26 quad_perm:[1,0,3,2] row_mask:0xf bank_mask:0xf
  s_nop 1
  v_add_f32_dpp v26, v26, v26 quad_perm:[2,3,0,1] row_mask:0xf bank_mask:0xf
  s_nop 1
  v_add_f32_dpp v26, v26, v26 row_half_mirror row_mask:0xf bank_mask:0xf
  v_cvt_pk_bf16_f32 v26, v26, v26
  v_and_b32 v26, s69, v26
  v_mul_f32 v26, 0x3db8aa3b, v26
  v_cmp_gt_f32 vcc, v26, v20
  s_cbranch_vccnz L_rescB
L_backB:
  v_sub_f32 v27, v26, v20
  v_exp_f32 v27, v27
  s_nop 0
  v_add_f32 v21, v21, v27
  v_mov_b32 v28, v27
  s_nop 1
  v_permlane16_swap_b32 v27, v28
  s_nop 1
  v_mov_b32_dpp v30, v27 row_newbcast:0 row_mask:0xf bank_mask:0xf
  v_mov_b32_dpp v31, v28 row_newbcast:0 row_mask:0xf bank_mask:0xf
  v_mov_b32_dpp v32, v27 row_newbcast:8 row_mask:0xf bank_mask:0xf
  v_mov_b32_dpp v33, v28 row_newbcast:8 row_mask:0xf bank_mask:0xf
  s_waitcnt vmcnt(12)
  v_lshlrev_b32 v34, 16, v112
  v_and_b32 v35, s69, v112
  v_lshlrev_b32 v36, 16, v113
  v_and_b32 v37, s69, v113
  v_lshlrev_b32 v38, 16, v114
  v_and_b32 v39, s69, v114
  v_lshlrev_b32 v40, 16, v115
  v_and_b32 v41, s69, v115
  v_pk_fma_f32 v[12:13], v[34:35], v[30:31], v[12:13] op_sel_hi:[1,0,1]
  v_pk_fma_f32 v[14:15], v[36:37], v[30:31], v[14:15] op_sel_hi:[1,0,1]
  v_pk_fma_f32 v[16:17], v[38:39], v[30:31], v[16:17] op_sel_hi:[1,0,1]
  v_pk_fma_f32 v[18:19], v[40:41], v[30:31], v[18:19] op_sel_hi:[1,0,1]
  v_lshlrev_b32 v34, 16, v116
  v_and_b32 v35, s69, v116
  v_lshlrev_b32 v36, 16, v117
  v_and_b32 v37, s69, v117
  v_lshlrev_b32 v38, 16, v118
  v_and_b32 v39, s69, v118
  v_lshlrev_b32 v40, 16, v119
  v_and_b32 v41, s69, v119
  v_pk_fma_f32 v[12:13], v[34:35], v[30:31], v[12:13] op_sel:[0,1,0] op_sel_hi:[1,1,1]
  v_pk_fma_f32 v[14:15], v[36:37], v[30:31], v[14:15] op_sel:[0,1,0] op_sel_hi:[1,1,1]
  v_pk_fma_f32 v[16:17], v[38:39], v[30:31], v[16:17] op_sel:[0,1,0] op_sel_hi:[1,1,1]
  v_pk_fma_f32 v[18:19], v[40:41], v[30:31], v[18:19] op_sel:[0,1,0] op_sel_hi:[1,1,1]
  v_lshlrev_b32 v34, 16, v120
  v_and_b32 v35, s69, v120
  v_lshlrev_b32 v36, 16, v121
  v_and_b32 v37, s69, v121
  v_lshlrev_b32 v38, 16, v122
  v_and_b32 v39, s69, v122
  v_lshlrev_b32 v40, 16, v123
  v_and_b32 v41, s69, v123
  v_pk_fma_f32 v[12:13], v[34:35], v[32:33], v[12:13] op_sel_hi:[1,0,1]
  v_pk_fma_f32 v[14:15], v[36:37], v[32:33], v[14:15] op_sel_hi:[1,0,1]
  v_pk_fma_f32 v[16:17], v[38:39], v[32:33], v[16:17] op_sel_hi:[1,0,1]
  v_pk_fma_f32 v[18:19], v[40:41], v[32:33], v[18:19] op_sel_hi:[1,0,1]
  v_lshlrev_b32 v34, 16, v124
  v_and_b32 v35, s69, v124
  v_lshlrev_b32 v36, 16, v125
  v_and_b32 v37, s69, v125
  v_lshlrev_b32 v38, 16, v126
  v_and_b32 v39, s69, v126
  v_lshlrev_b32 v40, 16, v127
  v_and_b32 v41, s69, v127
  v_pk_fma_f32 v[12:13], v[34:35], v[32:33], v[12:13] op_sel:[0,1,0] op_sel_hi:[1,1,1]
  v_pk_fma_f32 v[14:15], v[36:37], v[32:33], v[14:15] op_sel:[0,1,0] op_sel_hi:[1,1,1]
  v_pk_fma_f32 v[16:17], v[38:39], v[32:33], v[16:17] op_sel:[0,1,0] op_sel_hi:[1,1,1]
  v_pk_fma_f32 v[18:19], v[40:41], v[32:33], v[18:19] op_sel:[0,1,0] op_sel_hi:[1,1,1]
  buffer_load_dwordx4 v[112:115], v2, s[32:35], s88 offen offset:0 nt
  buffer_load_dwordx4 v[116:119], v2, s[32:35], s88 offen offset:1024 nt
  buffer_load_dwordx4 v[120:123], v2, s[32:35], s88 offen offset:2048 nt
  buffer_load_dwordx4 v[124:127], v2, s[32:35], s88 offen offset:3072 nt
  s_cmp_ge_u32 s65, 11
  s_cbranch_scc1 L_dyn
  s_cmp_lt_u32 s65, 11
  s_cbranch_scc1 L_job
L_jobret:
  s_add_u32 s65, s65, 1
  s_add_u32 s66, s66, 0x10000
  s_add_u32 s88, s88, 0x10000
  s_cmp_lt_u32 s65, 9
  s_cbranch_scc1 L_loop
  s_cmp_eq_u32 s65, 11
  s_cbranch_scc1 L_dyn0
  s_cmp_eq_u32 s65, 10
  s_cbranch_scc1 L_clm0
  s_lshl_b32 s67, s61, 4
  s_add_u32 s67, s67, 128
  v_mov_b32 v46, s67
  global_load_dword v46, v46, s[24:25] sc1
  s_branch L_loop
L_clm0:
  v_readfirstlane_b32 s67, v46
  v_mov_b32 v3, 48
  s_cmp_ge_u32 s60, 4
  s_cbranch_scc1 L_loop
  s_cmp_lt_u32 s67, 32
  s_cbranch_scc1 L_noclm
  v_mov_b32 v3, 1
  v_mov_b32 v46, 0
  s_mov_b64 exec, 1
  buffer_atomic_add v3, v46, s[56:59], s90 offen sc0 sc1
  s_mov_b64 exec, -1
  s_branch L_loop
L_dyn0:
  s_mov_b32 s89, 1
  s_barrier
L_dyn:
  s_cmp_eq_u32 s89, 0
  s_cbranch_scc1 L_epi
  v_readfirstlane_b32 s67, v3
  s_min_u32 s67, s67, 48
  s_lshl_b32 s66, s67, 13
  s_add_u32 s66, s66, 1703936
  s_add_u32 s88, s66, 0x1000
  s_cmp_lt_u32 s67, 48
  s_cselect_b32 s89, 1, 0
  s_cbranch_scc0 L_loop
  v_mov_b32 v3, 1
  v_mov_b32 v46, 0
  s_mov_b64 exec, 1
  buffer_atomic_add v3, v46, s[56:59], s90 offen sc0 sc1
  s_mov_b64 exec, -1
  s_branch L_loop
L_noclm:
  s_cmp_eq_u32 s63, 1
  s_cbranch_scc1 L_loop
  v_mov_b32 v46, 47296
L_nocl2:
  ds_read_b32 v3, v46
  s_waitcnt lgkmcnt(0)
  v_readfirstlane_b32 s67, v3
  s_cmp_lt_u32 s67, 8
  s_cbranch_scc1 L_nocl2
  v_mov_b32 v3, 1
  v_mov_b32 v46, 0
  s_mov_b64 exec, 1
  buffer_atomic_add v3, v46, s[56:59], s90 offen sc0 sc1
  s_mov_b64 exec, -1
  s_branch L_loop
L_rescA:
  v_max_f32 v28, v26, v20
  s_nop 1
  v_max_f32_dpp v28, v28, v28 row_ror:8 row_mask:0xf bank_mask:0xf
  s_nop 1
  v_max_f32_dpp v28, v28, v28 row_bcast:15 row_mask:0xa bank_mask:0xf
  s_nop 1
  v_max_f32_dpp v28, v28, v28 row_bcast:31 row_mask:0xc bank_mask:0xf
  s_nop 0
  v_readlane_b32 s67, v28, 63
  s_nop 1
  v_subrev_f32 v28, s67, v20
  v_exp_f32 v28, v28
  v_mov_b32 v20, s67
  v_mul_f32 v21, v21, v28
  v_pk_mul_f32 v[12:13], v[12:13], v[28:29] op_sel_hi:[1,0]
  v_pk_mul_f32 v[14:15], v[14:15], v[28:29] op_sel_hi:[1,0]
  v_pk_mul_f32 v[16:17], v[16:17], v[28:29] op_sel_hi:[1,0]
  v_pk_mul_f32 v[18:19], v[18:19], v[28:29] op_sel_hi:[1,0]
  s_branch L_backA
L_rescB:
  v_max_f32 v28, v26, v20
  s_nop 1
  v_max_f32_dpp v28, v28, v28 row_ror:8 row_mask:0xf bank_mask:0xf
  s_nop 1
  v_max_f32_dpp v28, v28, v28 row_bcast:15 row_mask:0xa bank_mask:0xf
  s_nop 1
  v_max_f32_dpp v28, v28, v28 row_bcast:31 row_mask:0xc bank_mask:0xf
  s_nop 0
  v_readlane_b32 s67, v28, 63
  s_nop 1
  v_subrev_f32 v28, s67, v20
  v_exp_f32 v28, v28
  v_mov_b32 v20, s67
  v_mul_f32 v21, v21, v28
  v_pk_mul_f32 v[12:13], v[12:13], v[28:29] op_sel_hi:[1,0]
  v_pk_mul_f32 v[14:15], v[14:15], v[28:29] op_sel_hi:[1,0]
  v_pk_mul_f32 v[16:17], v[16:17], v[28:29] op_sel_hi:[1,0]
  v_pk_mul_f32 v[18:19], v[18:19], v[28:29] op_sel_hi:[1,0]
  s_branch L_backB
L_rescC:
  v_max_f32 v28, v26, v20
  s_nop 1
  v_max_f32_dpp v28, v28, v28 row_ror:8 row_mask:0xf bank_mask:0xf
  s_nop 1
  v_max_f32_dpp v28, v28, v28 row_bcast:15 row_mask:0xa bank_mask:0xf
  s_nop 1
  v_max_f32_dpp v28, v28, v28 row_bcast:31 row_mask:0xc bank_mask:0xf
  s_nop 0
  v_readlane_b32 s67, v28, 63
  s_nop 1
  v_subrev_f32 v28, s67, v20
  v_exp_f32 v28, v28
  v_mov_b32 v20, s67
  v_mul_f32 v21, v21, v28
  v_pk_mul_f32 v[12:13], v[12:13], v[28:29] op_sel_hi:[1,0]
  v_pk_mul_f32 v[14:15], v[14:15], v[28:29] op_sel_hi:[1,0]
  v_pk_mul_f32 v[16:17], v[16:17], v[28:29] op_sel_hi:[1,0]
  v_pk_mul_f32 v[18:19], v[18:19], v[28:29] op_sel_hi:[1,0]
  s_branch L_backC
L_rescD:
  v_max_f32 v28, v26, v20
  s_nop 1
  v_max_f32_dpp v28, v28, v28 row_ror:8 row_mask:0xf bank_mask:0xf
  s_nop 1
  v_max_f32_dpp v28, v28, v28 row_bcast:15 row_mask:0xa bank_mask:0xf
  s_nop 1
  v_max_f32_dpp v28, v28, v28 row_bcast:31 row_mask:0xc bank_mask:0xf
  s_nop 0
  v_readlane_b32 s67, v28, 63
  s_nop 1
  v_subrev_f32 v28, s67, v20
  v_exp_f32 v28, v28
  v_mov_b32 v20, s67
  v_mul_f32 v21, v21, v28
  v_pk_mul_f32 v[12:13], v[12:13], v[28:29] op_sel_hi:[1,0]
  v_pk_mul_f32 v[14:15], v[14:15], v[28:29] op_sel_hi:[1,0]
  v_pk_mul_f32 v[16:17], v[16:17], v[28:29] op_sel_hi:[1,0]
  v_pk_mul_f32 v[18:19], v[18:19], v[28:29] op_sel_hi:[1,0]
  s_branch L_backD
L_job:
  s_cmp_eq_u32 s65, 0
  s_cbranch_scc1 L_job0
  s_cmp_gt_u32 s65, 8
  s_cbranch_scc1 L_jobwd
  s_set_gpr_idx_on s92, 0x8
  s_nop 0
  v_perm_b32 v128, v52, v48, s93
  v_perm_b32 v129, v52, v48, s94
  v_perm_b32 v130, v53, v49, s93
  v_perm_b32 v131, v53, v49, s94
  v_perm_b32 v132, v54, v50, s93
  v_perm_b32 v133, v54, v50, s94
  v_perm_b32 v134, v55, v51, s93
  v_perm_b32 v135, v55, v51, s94
  v_perm_b32 v136, v60, v56, s93
  v_perm_b32 v137, v60, v56, s94
  v_perm_b32 v138, v61, v57, s93
  v_perm_b32 v139, v61, v57, s94
  v_perm_b32 v140, v62, v58, s93
  v_perm_b32 v141, v62, v58, s94
  v_perm_b32 v142, v63, v59, s93
  v_perm_b32 v143, v63, v59, s94
  s_set_gpr_idx_off
  s_add_u32 s92, s92, 16
  s_cmp_eq_u32 s65, 8
  s_cbranch_scc1 L_job8
  s_cmp_eq_u32 s65, 4
  s_cbranch_scc1 L_job4
  buffer_load_dwordx4 v[48:51], v2, s[48:51], s91 offen offset:0
  buffer_load_dwordx4 v[52:55], v2, s[48:51], s91 offen offset:896
  buffer_load_dwordx4 v[56:59], v2, s[48:51], s91 offen offset:1792
  buffer_load_dwordx4 v[60:63], v2, s[48:51], s91 offen offset:2688
  s_add_u32 s91, s91, 3584
  s_cmp_gt_u32 s65, 3
  s_cbranch_scc1 L_jobret
  s_cmp_eq_u32 s65, 2
  s_cbranch_scc1 L_job2
  s_cmp_eq_u32 s65, 3
  s_cbranch_scc1 L_job3
  buffer_load_dwordx4 v[208:211], v4, s[40:43], s87 offen
  s_add_u32 s87, s87, 28672
  buffer_load_dwordx4 v[212:215], v4, s[40:43], s87 offen
  s_add_u32 s87, s87, 28672
  buffer_load_dwordx4 v[216:219], v4, s[40:43], s87 offen
  s_add_u32 s87, s87, 28672
  buffer_load_dwordx4 v[220:223], v4, s[40:43], s87 offen
  s_add_u32 s87, s87, 28672
  s_branch L_jobret
L_job2:
  buffer_load_dwordx4 v[224:227], v4, s[40:43], s87 offen
  s_add_u32 s87, s87, 28672
  buffer_load_dwordx4 v[228:231], v4, s[40:43], s87 offen
  s_add_u32 s87, s87, 28672
  buffer_load_dwordx4 v[232:235], v4, s[40:43], s87 offen
  s_add_u32 s87, s87, 28672
  s_branch L_jobret
L_job3:
  buffer_load_dwordx4 v[236:239], v4, s[40:43], s87 offen
  s_add_u32 s87, s87, 28672
  buffer_load_dwordx4 v[240:243], v4, s[40:43], s87 offen
  s_add_u32 s87, s87, 28672
  buffer_load_dwordx4 v[244:247], v4, s[40:43], s87 offen
  s_add_u32 s87, s87, 28672
  s_branch L_jobret
L_job8:
  s_lshl_b32 s67, s64, 6
  s_lshl_b32 s68, s60, 3
  s_add_u32 s67, s67, s68
  s_mul_i32 s91, s67, 896
  buffer_load_dwordx4 v[48:51], v2, s[52:55], s91 offen offset:0
  buffer_load_dwordx4 v[52:55], v2, s[52:55], s91 offen offset:896
  buffer_load_dwordx4 v[56:59], v2, s[52:55], s91 offen offset:1792
  buffer_load_dwordx4 v[60:63], v2, s[52:55], s91 offen offset:2688
  s_add_u32 s91, s91, 3584
  s_branch L_jobret
L_job0:
  s_waitcnt vmcnt(16)
  s_cmp_lg_u32 s60, 1
  s_cbranch_scc1 L_nocnt
  s_lshl_b32 s67, s61, 4
  s_add_u32 s67, s67, 128
  v_mov_b32 v22, s67
  v_mov_b32 v23, 1
  s_mov_b64 exec, 1
  global_atomic_add v22, v23, s[24:25] sc1
  s_mov_b64 exec, -1
L_nocnt:
  s_lshl_b32 s67, s62, 8
  s_lshl_b32 s68, s60, 5
  s_add_u32 s67, s67, s68
  s_mul_i32 s91, s67, 896
  s_mov_b32 s92, 0
  buffer_load_dwordx4 v[48:51], v2, s[48:51], s91 offen offset:0
  buffer_load_dwordx4 v[52:55], v2, s[48:51], s91 offen offset:896
  buffer_load_dwordx4 v[56:59], v2, s[48:51], s91 offen offset:1792
  buffer_load_dwordx4 v[60:63], v2, s[48:51], s91 offen offset:2688
  s_add_u32 s91, s91, 3584
  buffer_load_dwordx4 v[192:195], v4, s[40:43], s87 offen
  s_add_u32 s87, s87, 28672
  buffer_load_dwordx4 v[196:199], v4, s[40:43], s87 offen
  s_add_u32 s87, s87, 28672
  buffer_load_dwordx4 v[200:203], v4, s[40:43], s87 offen
  s_add_u32 s87, s87, 28672
  buffer_load_dwordx4 v[204:207], v4, s[40:43], s87 offen
  s_add_u32 s87, s87, 28672
  v_dot2_f32_bf16 v22, v128, v8, 0
  v_dot2_f32_bf16 v23, v132, v8, 0
  v_dot2_f32_bf16 v24, v136, v8, 0
  v_dot2_f32_bf16 v25, v140, v8, 0
  v_dot2c_f32_bf16 v22, v129, v9
  v_dot2c_f32_bf16 v23, v133, v9
  v_dot2c_f32_bf16 v24, v137, v9
  v_dot2c_f32_bf16 v25, v141, v9
  v_dot2c_f32_bf16 v22, v130, v10
  v_dot2c_f32_bf16 v23, v134, v10
  v_dot2c_f32_bf16 v24, v138, v10
  v_dot2c_f32_bf16 v25, v142, v10
  v_dot2c_f32_bf16 v22, v131, v11
  v_dot2c_f32_bf16 v23, v135, v11
  v_dot2c_f32_bf16 v24, v139, v11
  v_dot2c_f32_bf16 v25, v143, v11
  s_nop 2
  v_permlane16_swap_b32 v22, v23
  v_permlane16_swap_b32 v24, v25
  s_nop 0
  v_add_f32 v22, v22, v23
  v_add_f32 v24, v24, v25
  s_nop 0
  v_add_f32_dpp v26, v22, v22 row_ror:8 row_mask:0xf bank_mask:0x3
  v_add_f32_dpp v26, v24, v24 row_ror:8 row_mask:0xf bank_mask:0xc
  s_nop 1
  v_add_f32_dpp v26, v26, v26 quad_perm:[1,0,3,2] row_mask:0xf bank_mask:0xf
  s_nop 1
  v_add_f32_dpp v26, v26, v26 quad_perm:[2,3,0,1] row_mask:0xf bank_mask:0xf
  s_nop 1
  v_add_f32_dpp v26, v26, v26 row_half_mirror row_mask:0xf bank_mask:0xf
  v_cvt_pk_bf16_f32 v26, v26, v26
  v_and_b32 v26, s69, v26
  v_mul_f32 v26, 0x3db8aa3b, v26
  v_cmp_gt_f32 vcc, v26, v20
  s_cbranch_vccnz L_rescC
L_backC:
  v_sub_f32 v27, v26, v20
  v_exp_f32 v27, v27
  s_nop 0
  v_add_f32 v21, v21, v27
  v_mov_b32 v28, v27
  s_nop 1
  v_permlane16_swap_b32 v27, v28
  s_nop 1
  v_mov_b32_dpp v30, v27 row_newbcast:0 row_mask:0xf bank_mask:0xf
  v_mov_b32_dpp v31, v28 row_newbcast:0 row_mask:0xf bank_mask:0xf
  v_mov_b32_dpp v32, v27 row_newbcast:8 row_mask:0xf bank_mask:0xf
  v_mov_b32_dpp v33, v28 row_newbcast:8 row_mask:0xf bank_mask:0xf
  v_lshlrev_b32 v34, 16, v144
  v_and_b32 v35, s69, v144
  v_lshlrev_b32 v36, 16, v145
  v_and_b32 v37, s69, v145
  v_lshlrev_b32 v38, 16, v146
  v_and_b32 v39, s69, v146
  v_lshlrev_b32 v40, 16, v147
  v_and_b32 v41, s69, v147
  v_pk_fma_f32 v[12:13], v[34:35], v[30:31], v[12:13] op_sel_hi:[1,0,1]
  v_pk_fma_f32 v[14:15], v[36:37], v[30:31], v[14:15] op_sel_hi:[1,0,1]
  v_pk_fma_f32 v[16:17], v[38:39], v[30:31], v[16:17] op_sel_hi:[1,0,1]
  v_pk_fma_f32 v[18:19], v[40:41], v[30:31], v[18:19] op_sel_hi:[1,0,1]
  v_lshlrev_b32 v34, 16, v148
  v_and_b32 v35, s69, v148
  v_lshlrev_b32 v36, 16, v149
  v_and_b32 v37, s69, v149
  v_lshlrev_b32 v38, 16, v150
  v_and_b32 v39, s69, v150
  v_lshlrev_b32 v40, 16, v151
  v_and_b32 v41, s69, v151
  v_pk_fma_f32 v[12:13], v[34:35], v[30:31], v[12:13] op_sel:[0,1,0] op_sel_hi:[1,1,1]
  v_pk_fma_f32 v[14:15], v[36:37], v[30:31], v[14:15] op_sel:[0,1,0] op_sel_hi:[1,1,1]
  v_pk_fma_f32 v[16:17], v[38:39], v[30:31], v[16:17] op_sel:[0,1,0] op_sel_hi:[1,1,1]
  v_pk_fma_f32 v[18:19], v[40:41], v[30:31], v[18:19] op_sel:[0,1,0] op_sel_hi:[1,1,1]
  v_lshlrev_b32 v34, 16, v152
  v_and_b32 v35, s69, v152
  v_lshlrev_b32 v36, 16, v153
  v_and_b32 v37, s69, v153
  v_lshlrev_b32 v38, 16, v154
  v_and_b32 v39, s69, v154
  v_lshlrev_b32 v40, 16, v155
  v_and_b32 v41, s69, v155
  v_pk_fma_f32 v[12:13], v[34:35], v[32:33], v[12:13] op_sel_hi:[1,0,1]
  v_pk_fma_f32 v[14:15], v[36:37], v[32:33], v[14:15] op_sel_hi:[1,0,1]
  v_pk_fma_f32 v[16:17], v[38:39], v[32:33], v[16:17] op_sel_hi:[1,0,1]
  v_pk_fma_f32 v[18:19], v[40:41], v[32:33], v[18:19] op_sel_hi:[1,0,1]
  v_lshlrev_b32 v34, 16, v156
  v_and_b32 v35, s69, v156
  v_lshlrev_b32 v36, 16, v157
  v_and_b32 v37, s69, v157
  v_lshlrev_b32 v38, 16, v158
  v_and_b32 v39, s69, v158
  v_lshlrev_b32 v40, 16, v159
  v_and_b32 v41, s69, v159
  v_pk_fma_f32 v[12:13], v[34:35], v[32:33], v[12:13] op_sel:[0,1,0] op_sel_hi:[1,1,1]
  v_pk_fma_f32 v[14:15], v[36:37], v[32:33], v[14:15] op_sel:[0,1,0] op_sel_hi:[1,1,1]
  v_pk_fma_f32 v[16:17], v[38:39], v[32:33], v[16:17] op_sel:[0,1,0] op_sel_hi:[1,1,1]
  v_pk_fma_f32 v[18:19], v[40:41], v[32:33], v[18:19] op_sel:[0,1,0] op_sel_hi:[1,1,1]
  v_dot2_f32_bf16 v22, v160, v8, 0
  v_dot2_f32_bf16 v23, v164, v8, 0
  v_dot2_f32_bf16 v24, v168, v8, 0
  v_dot2_f32_bf16 v25, v172, v8, 0
  v_dot2c_f32_bf16 v22, v161, v9
  v_dot2c_f32_bf16 v23, v165, v9
  v_dot2c_f32_bf16 v24, v169, v9
  v_dot2c_f32_bf16 v25, v173, v9
  v_dot2c_f32_bf16 v22, v162, v10
  v_dot2c_f32_bf16 v23, v166, v10
  v_dot2c_f32_bf16 v24, v170, v10
  v_dot2c_f32_bf16 v25, v174, v10
  v_dot2c_f32_bf16 v22, v163, v11
  v_dot2c_f32_bf16 v23, v167, v11
  v_dot2c_f32_bf16 v24, v171, v11
  v_dot2c_f32_bf16 v25, v175, v11
  s_nop 2
  v_permlane16_swap_b32 v22, v23
  v_permlane16_swap_b32 v24, v25
  s_nop 0
  v_add_f32 v22, v22, v23
  v_add_f32 v24, v24, v25
  s_nop 0
  v_add_f32_dpp v26, v22, v22 row_ror:8 row_mask:0xf bank_mask:0x3
  v_add_f32_dpp v26, v24, v24 row_ror:8 row_mask:0xf bank_mask:0xc
  s_nop 1
  v_add_f32_dpp v26, v26, v26 quad_perm:[1,0,3,2] row_mask:0xf bank_mask:0xf
  s_nop 1
  v_add_f32_dpp v26, v26, v26 quad_perm:[2,3,0,1] row_mask:0xf bank_mask:0xf
  s_nop 1
  v_add_f32_dpp v26, v26, v26 row_half_mirror row_mask:0xf bank_mask:0xf
  v_cvt_pk_bf16_f32 v26, v26, v26
  v_and_b32 v26, s69, v26
  v_mul_f32 v26, 0x3db8aa3b, v26
  v_cmp_gt_f32 vcc, v26, v20
  s_cbranch_vccnz L_rescD
L_backD:
  v_sub_f32 v27, v26, v20
  v_exp_f32 v27, v27
  s_nop 0
  v_add_f32 v21, v21, v27
  v_mov_b32 v28, v27
  s_nop 1
  v_permlane16_swap_b32 v27, v28
  s_nop 1
  v_mov_b32_dpp v30, v27 row_newbcast:0 row_mask:0xf bank_mask:0xf
  v_mov_b32_dpp v31, v28 row_newbcast:0 row_mask:0xf bank_mask:0xf
  v_mov_b32_dpp v32, v27 row_newbcast:8 row_mask:0xf bank_mask:0xf
  v_mov_b32_dpp v33, v28 row_newbcast:8 row_mask:0xf bank_mask:0xf
  v_lshlrev_b32 v34, 16, v176
  v_and_b32 v35, s69, v176
  v_lshlrev_b32 v36, 16, v177
  v_and_b32 v37, s69, v177
  v_lshlrev_b32 v38, 16, v178
  v_and_b32 v39, s69, v178
  v_lshlrev_b32 v40, 16, v179
  v_and_b32 v41, s69, v179
  v_pk_fma_f32 v[12:13], v[34:35], v[30:31], v[12:13] op_sel_hi:[1,0,1]
  v_pk_fma_f32 v[14:15], v[36:37], v[30:31], v[14:15] op_sel_hi:[1,0,1]
  v_pk_fma_f32 v[16:17], v[38:39], v[30:31], v[16:17] op_sel_hi:[1,0,1]
  v_pk_fma_f32 v[18:19], v[40:41], v[30:31], v[18:19] op_sel_hi:[1,0,1]
  v_lshlrev_b32 v34, 16, v180
  v_and_b32 v35, s69, v180
  v_lshlrev_b32 v36, 16, v181
  v_and_b32 v37, s69, v181
  v_lshlrev_b32 v38, 16, v182
  v_and_b32 v39, s69, v182
  v_lshlrev_b32 v40, 16, v183
  v_and_b32 v41, s69, v183
  v_pk_fma_f32 v[12:13], v[34:35], v[30:31], v[12:13] op_sel:[0,1,0] op_sel_hi:[1,1,1]
  v_pk_fma_f32 v[14:15], v[36:37], v[30:31], v[14:15] op_sel:[0,1,0] op_sel_hi:[1,1,1]
  v_pk_fma_f32 v[16:17], v[38:39], v[30:31], v[16:17] op_sel:[0,1,0] op_sel_hi:[1,1,1]
  v_pk_fma_f32 v[18:19], v[40:41], v[30:31], v[18:19] op_sel:[0,1,0] op_sel_hi:[1,1,1]
  v_lshlrev_b32 v34, 16, v184
  v_and_b32 v35, s69, v184
  v_lshlrev_b32 v36, 16, v185
  v_and_b32 v37, s69, v185
  v_lshlrev_b32 v38, 16, v186
  v_and_b32 v39, s69, v186
  v_lshlrev_b32 v40, 16, v187
  v_and_b32 v41, s69, v187
  v_pk_fma_f32 v[12:13], v[34:35], v[32:33], v[12:13] op_sel_hi:[1,0,1]
  v_pk_fma_f32 v[14:15], v[36:37], v[32:33], v[14:15] op_sel_hi:[1,0,1]
  v_pk_fma_f32 v[16:17], v[38:39], v[32:33], v[16:17] op_sel_hi:[1,0,1]
  v_pk_fma_f32 v[18:19], v[40:41], v[32:33], v[18:19] op_sel_hi:[1,0,1]
  v_lshlrev_b32 v34, 16, v188
  v_and_b32 v35, s69, v188
  v_lshlrev_b32 v36, 16, v189
  v_and_b32 v37, s69, v189
  v_lshlrev_b32 v38, 16, v190
  v_and_b32 v39, s69, v190
  v_lshlrev_b32 v40, 16, v191
  v_and_b32 v41, s69, v191
  v_pk_fma_f32 v[12:13], v[34:35], v[32:33], v[12:13] op_sel:[0,1,0] op_sel_hi:[1,1,1]
  v_pk_fma_f32 v[14:15], v[36:37], v[32:33], v[14:15] op_sel:[0,1,0] op_sel_hi:[1,1,1]
  v_pk_fma_f32 v[16:17], v[38:39], v[32:33], v[16:17] op_sel:[0,1,0] op_sel_hi:[1,1,1]
  v_pk_fma_f32 v[18:19], v[40:41], v[32:33], v[18:19] op_sel:[0,1,0] op_sel_hi:[1,1,1]
  s_branch L_jobret
L_job4:
  v_lshrrev_b32 v5, 3, v1
  v_lshlrev_b32 v5, 2, v5
  s_and_b32 s67, s60, 3
  s_mul_i32 s67, s67, 448
  s_lshl_b32 s68, s61, 11
  s_add_u32 s67, s67, s68
  v_add_u32 v5, s67, v5
  ds_read2_b32 v[22:23], v5 offset0:0 offset1:8
  ds_read2_b32 v[24:25], v5 offset0:16 offset1:24
  ds_read2_b32 v[26:27], v5 offset0:32 offset1:40
  ds_read2_b32 v[28:29], v5 offset0:48 offset1:56
  ds_read2_b32 v[30:31], v5 offset0:64 offset1:72
  ds_read2_b32 v[32:33], v5 offset0:80 offset1:88
  ds_read2_b32 v[34:35], v5 offset0:96 offset1:104
  v_mov_b32 v38, 0
  v_mov_b32 v39, 0
  v_mov_b32 v40, 0
  v_mov_b32 v41, 0
  v_mov_b32 v42, 0
  v_mov_b32 v43, 0
  v_mov_b32 v44, 0
  v_mov_b32 v45, 0
  s_waitcnt lgkmcnt(0)
  v_lshlrev_b32 v48, 16, v192
  v_and_b32 v49, s69, v192
  v_lshlrev_b32 v50, 16, v193
  v_and_b32 v51, s69, v193
  v_lshlrev_b32 v52, 16, v194
  v_and_b32 v53, s69, v194
  v_lshlrev_b32 v54, 16, v195
  v_and_b32 v55, s69, v195
  v_pk_fma_f32 v[38:39], v[48:49], v[22:23], v[38:39] op_sel_hi:[1,0,1]
  v_pk_fma_f32 v[40:41], v[50:51], v[22:23], v[40:41] op_sel_hi:[1,0,1]
  v_pk_fma_f32 v[42:43], v[52:53], v[22:23], v[42:43] op_sel_hi:[1,0,1]
  v_pk_fma_f32 v[44:45], v[54:55], v[22:23], v[44:45] op_sel_hi:[1,0,1]
  v_lshlrev_b32 v48, 16, v196
  v_and_b32 v49, s69, v196
  v_lshlrev_b32 v50, 16, v197
  v_and_b32 v51, s69, v197
  v_lshlrev_b32 v52, 16, v198
  v_and_b32 v53, s69, v198
  v_lshlrev_b32 v54, 16, v199
  v_and_b32 v55, s69, v199
  v_pk_fma_f32 v[38:39], v[48:49], v[22:23], v[38:39] op_sel:[0,1,0] op_sel_hi:[1,1,1]
  v_pk_fma_f32 v[40:41], v[50:51], v[22:23], v[40:41] op_sel:[0,1,0] op_sel_hi:[1,1,1]
  v_pk_fma_f32 v[42:43], v[52:53], v[22:23], v[42:43] op_sel:[0,1,0] op_sel_hi:[1,1,1]
  v_pk_fma_f32 v[44:45], v[54:55], v[22:23], v[44:45] op_sel:[0,1,0] op_sel_hi:[1,1,1]
  v_lshlrev_b32 v48, 16, v200
  v_and_b32 v49, s69, v200
  v_lshlrev_b32 v50, 16, v201
  v_and_b32 v51, s69, v201
  v_lshlrev_b32 v52, 16, v202
  v_and_b32 v53, s69, v202
  v_lshlrev_b32 v54, 16, v203
  v_and_b32 v55, s69, v203
  v_pk_fma_f32 v[38:39], v[48:49], v[24:25], v[38:39] op_sel_hi:[1,0,1]
  v_pk_fma_f32 v[40:41], v[50:51], v[24:25], v[40:41] op_sel_hi:[1,0,1]
  v_pk_fma_f32 v[42:43], v[52:53], v[24:25], v[42:43] op_sel_hi:[1,0,1]
  v_pk_fma_f32 v[44:45], v[54:55], v[24:25], v[44:45] op_sel_hi:[1,0,1]
  v_lshlrev_b32 v48, 16, v204
  v_and_b32 v49, s69, v204
  v_lshlrev_b32 v50, 16, v205
  v_and_b32 v51, s69, v205
  v_lshlrev_b32 v52, 16, v206
  v_and_b32 v53, s69, v206
  v_lshlrev_b32 v54, 16, v207
  v_and_b32 v55, s69, v207
  v_pk_fma_f32 v[38:39], v[48:49], v[24:25], v[38:39] op_sel:[0,1,0] op_sel_hi:[1,1,1]
  v_pk_fma_f32 v[40:41], v[50:51], v[24:25], v[40:41] op_sel:[0,1,0] op_sel_hi:[1,1,1]
  v_pk_fma_f32 v[42:43], v[52:53], v[24:25], v[42:43] op_sel:[0,1,0] op_sel_hi:[1,1,1]
  v_pk_fma_f32 v[44:45], v[54:55], v[24:25], v[44:45] op_sel:[0,1,0] op_sel_hi:[1,1,1]
  v_lshlrev_b32 v48, 16, v208
  v_and_b32 v49, s69, v208
  v_lshlrev_b32 v50, 16, v209
  v_and_b32 v51, s69, v209
  v_lshlrev_b32 v52, 16, v210
  v_and_b32 v53, s69, v210
  v_lshlrev_b32 v54, 16, v211
  v_and_b32 v55, s69, v211
  v_pk_fma_f32 v[38:39], v[48:49], v[26:27], v[38:39] op_sel_hi:[1,0,1]
  v_pk_fma_f32 v[40:41], v[50:51], v[26:27], v[40:41] op_sel_hi:[1,0,1]
  v_pk_fma_f32 v[42:43], v[52:53], v[26:27], v[42:43] op_sel_hi:[1,0,1]
  v_pk_fma_f32 v[44:45], v[54:55], v[26:27], v[44:45] op_sel_hi:[1,0,1]
  v_lshlrev_b32 v48, 16, v212
  v_and_b32 v49, s69, v212
  v_lshlrev_b32 v50, 16, v213
  v_and_b32 v51, s69, v213
  v_lshlrev_b32 v52, 16, v214
  v_and_b32 v53, s69, v214
  v_lshlrev_b32 v54, 16, v215
  v_and_b32 v55, s69, v215
  v_pk_fma_f32 v[38:39], v[48:49], v[26:27], v[38:39] op_sel:[0,1,0] op_sel_hi:[1,1,1]
  v_pk_fma_f32 v[40:41], v[50:51], v[26:27], v[40:41] op_sel:[0,1,0] op_sel_hi:[1,1,1]
  v_pk_fma_f32 v[42:43], v[52:53], v[26:27], v[42:43] op_sel:[0,1,0] op_sel_hi:[1,1,1]
  v_pk_fma_f32 v[44:45], v[54:55], v[26:27], v[44:45] op_sel:[0,1,0] op_sel_hi:[1,1,1]
  v_lshlrev_b32 v48, 16, v216
  v_and_b32 v49, s69, v216
  v_lshlrev_b32 v50, 16, v217
  v_and_b32 v51, s69, v217
  v_lshlrev_b32 v52, 16, v218
  v_and_b32 v53, s69, v218
  v_lshlrev_b32 v54, 16, v219
  v_and_b32 v55, s69, v219
  v_pk_fma_f32 v[38:39], v[48:49], v[28:29], v[38:39] op_sel_hi:[1,0,1]
  v_pk_fma_f32 v[40:41], v[50:51], v[28:29], v[40:41] op_sel_hi:[1,0,1]
  v_pk_fma_f32 v[42:43], v[52:53], v[28:29], v[42:43] op_sel_hi:[1,0,1]
  v_pk_fma_f32 v[44:45], v[54:55], v[28:29], v[44:45] op_sel_hi:[1,0,1]
  v_lshlrev_b32 v48, 16, v220
  v_and_b32 v49, s69, v220
  v_lshlrev_b32 v50, 16, v221
  v_and_b32 v51, s69, v221
  v_lshlrev_b32 v52, 16, v222
  v_and_b32 v53, s69, v222
  v_lshlrev_b32 v54, 16, v223
  v_and_b32 v55, s69, v223
  v_pk_fma_f32 v[38:39], v[48:49], v[28:29], v[38:39] op_sel:[0,1,0] op_sel_hi:[1,1,1]
  v_pk_fma_f32 v[40:41], v[50:51], v[28:29], v[40:41] op_sel:[0,1,0] op_sel_hi:[1,1,1]
  v_pk_fma_f32 v[42:43], v[52:53], v[28:29], v[42:43] op_sel:[0,1,0] op_sel_hi:[1,1,1]
  v_pk_fma_f32 v[44:45], v[54:55], v[28:29], v[44:45] op_sel:[0,1,0] op_sel_hi:[1,1,1]
  v_lshlrev_b32 v48, 16, v224
  v_and_b32 v49, s69, v224
  v_lshlrev_b32 v50, 16, v225
  v_and_b32 v51, s69, v225
  v_lshlrev_b32 v52, 16, v226
  v_and_b32 v53, s69, v226
  v_lshlrev_b32 v54, 16, v227
  v_and_b32 v55, s69, v227
  v_pk_fma_f32 v[38:39], v[48:49], v[30:31], v[38:39] op_sel_hi:[1,0,1]
  v_pk_fma_f32 v[40:41], v[50:51], v[30:31], v[40:41] op_sel_hi:[1,0,1]
  v_pk_fma_f32 v[42:43], v[52:53], v[30:31], v[42:43] op_sel_hi:[1,0,1]
  v_pk_fma_f32 v[44:45], v[54:55], v[30:31], v[44:45] op_sel_hi:[1,0,1]
  v_lshlrev_b32 v48, 16, v228
  v_and_b32 v49, s69, v228
  v_lshlrev_b32 v50, 16, v229
  v_and_b32 v51, s69, v229
  v_lshlrev_b32 v52, 16, v230
  v_and_b32 v53, s69, v230
  v_lshlrev_b32 v54, 16, v231
  v_and_b32 v55, s69, v231
  v_pk_fma_f32 v[38:39], v[48:49], v[30:31], v[38:39] op_sel:[0,1,0] op_sel_hi:[1,1,1]
  v_pk_fma_f32 v[40:41], v[50:51], v[30:31], v[40:41] op_sel:[0,1,0] op_sel_hi:[1,1,1]
  v_pk_fma_f32 v[42:43], v[52:53], v[30:31], v[42:43] op_sel:[0,1,0] op_sel_hi:[1,1,1]
  v_pk_fma_f32 v[44:45], v[54:55], v[30:31], v[44:45] op_sel:[0,1,0] op_sel_hi:[1,1,1]
  v_lshlrev_b32 v48, 16, v232
  v_and_b32 v49, s69, v232
  v_lshlrev_b32 v50, 16, v233
  v_and_b32 v51, s69, v233
  v_lshlrev_b32 v52, 16, v234
  v_and_b32 v53, s69, v234
  v_lshlrev_b32 v54, 16, v235
  v_and_b32 v55, s69, v235
  v_pk_fma_f32 v[38:39], v[48:49], v[32:33], v[38:39] op_sel_hi:[1,0,1]
  v_pk_fma_f32 v[40:41], v[50:51], v[32:33], v[40:41] op_sel_hi:[1,0,1]
  v_pk_fma_f32 v[42:43], v[52:53], v[32:33], v[42:43] op_sel_hi:[1,0,1]
  v_pk_fma_f32 v[44:45], v[54:55], v[32:33], v[44:45] op_sel_hi:[1,0,1]
  v_lshlrev_b32 v48, 16, v236
  v_and_b32 v49, s69, v236
  v_lshlrev_b32 v50, 16, v237
  v_and_b32 v51, s69, v237
  v_lshlrev_b32 v52, 16, v238
  v_and_b32 v53, s69, v238
  v_lshlrev_b32 v54, 16, v239
  v_and_b32 v55, s69, v239
  v_pk_fma_f32 v[38:39], v[48:49], v[32:33], v[38:39] op_sel:[0,1,0] op_sel_hi:[1,1,1]
  v_pk_fma_f32 v[40:41], v[50:51], v[32:33], v[40:41] op_sel:[0,1,0] op_sel_hi:[1,1,1]
  v_pk_fma_f32 v[42:43], v[52:53], v[32:33], v[42:43] op_sel:[0,1,0] op_sel_hi:[1,1,1]
  v_pk_fma_f32 v[44:45], v[54:55], v[32:33], v[44:45] op_sel:[0,1,0] op_sel_hi:[1,1,1]
  v_lshlrev_b32 v48, 16, v240
  v_and_b32 v49, s69, v240
  v_lshlrev_b32 v50, 16, v241
  v_and_b32 v51, s69, v241
  v_lshlrev_b32 v52, 16, v242
  v_and_b32 v53, s69, v242
  v_lshlrev_b32 v54, 16, v243
  v_and_b32 v55, s69, v243
  v_pk_fma_f32 v[38:39], v[48:49], v[34:35], v[38:39] op_sel_hi:[1,0,1]
  v_pk_fma_f32 v[40:41], v[50:51], v[34:35], v[40:41] op_sel_hi:[1,0,1]
  v_pk_fma_f32 v[42:43], v[52:53], v[34:35], v[42:43] op_sel_hi:[1,0,1]
  v_pk_fma_f32 v[44:45], v[54:55], v[34:35], v[44:45] op_sel_hi:[1,0,1]
  v_lshlrev_b32 v48, 16, v244
  v_and_b32 v49, s69, v244
  v_lshlrev_b32 v50, 16, v245
  v_and_b32 v51, s69, v245
  v_lshlrev_b32 v52, 16, v246
  v_and_b32 v53, s69, v246
  v_lshlrev_b32 v54, 16, v247
  v_and_b32 v55, s69, v247
  v_pk_fma_f32 v[38:39], v[48:49], v[34:35], v[38:39] op_sel:[0,1,0] op_sel_hi:[1,1,1]
  v_pk_fma_f32 v[40:41], v[50:51], v[34:35], v[40:41] op_sel:[0,1,0] op_sel_hi:[1,1,1]
  v_pk_fma_f32 v[42:43], v[52:53], v[34:35], v[42:43] op_sel:[0,1,0] op_sel_hi:[1,1,1]
  v_pk_fma_f32 v[44:45], v[54:55], v[34:35], v[44:45] op_sel:[0,1,0] op_sel_hi:[1,1,1]
  buffer_load_dwordx4 v[48:51], v2, s[48:51], s91 offen offset:0
  buffer_load_dwordx4 v[52:55], v2, s[48:51], s91 offen offset:896
  buffer_load_dwordx4 v[56:59], v2, s[48:51], s91 offen offset:1792
  buffer_load_dwordx4 v[60:63], v2, s[48:51], s91 offen offset:2688
  s_add_u32 s91, s91, 3584
  v_permlane32_swap_b32 v38, v42
  v_permlane32_swap_b32 v39, v43
  v_permlane32_swap_b32 v40, v44
  v_permlane32_swap_b32 v41, v45
  s_nop 0
  v_add_f32 v38, v38, v42
  v_add_f32 v39, v39, v43
  v_add_f32 v40, v40, v44
  v_add_f32 v41, v41, v45
  s_nop 0
  v_permlane16_swap_b32 v38, v40
  v_permlane16_swap_b32 v39, v41
  s_nop 0
  v_add_f32 v38, v38, v40
  v_add_f32 v39, v39, v41
  v_and_b32 v22, 7, v1
  v_lshrrev_b32 v23, 3, v1
  v_add_f32_dpp v42, v38, v38 row_ror:8 row_mask:0xf bank_mask:0x3
  v_add_f32_dpp v42, v39, v39 row_ror:8 row_mask:0xf bank_mask:0xc
  v_lshl_add_u32 v22, v22, 3, v23
  v_lshlrev_b32 v22, 2, v22
  s_lshl_b32 s67, s60, 8
  v_add_u32 v22, s67, v22
  ds_write_b32 v22, v42 offset:20480
  v_mov_b32 v24, 47296
  v_mov_b32 v25, 1
  s_waitcnt lgkmcnt(0)
  s_mov_b64 exec, 1
  ds_add_u32 v24, v25
  s_mov_b64 exec, -1
  s_branch L_jobret
L_jobwd:
  v_lshlrev_b32 v5, 5, v1
  s_lshl_b32 s67, s60, 11
  v_add_u32 v5, s67, v5
  s_cmp_eq_u32 s65, 10
  s_cbranch_scc1 L_job10
  v_mov_b32 v22, 47296
L_cntspin:
  ds_read_b32 v23, v22
  s_waitcnt lgkmcnt(0)
  v_readfirstlane_b32 s67, v23
  s_cmp_ge_u32 s67, 8
  s_cbranch_scc1 L_cntok
  s_sleep 16
  s_branch L_cntspin
L_cntok:
  v_lshlrev_b32 v30, 2, v1
  v_add_u32 v30, 20480, v30
  ds_read2st64_b32 v[22:23], v30 offset0:0 offset1:1
  ds_read2st64_b32 v[24:25], v30 offset0:2 offset1:3
  ds_read2st64_b32 v[26:27], v30 offset0:4 offset1:5
  ds_read2st64_b32 v[28:29], v30 offset0:6 offset1:7
  v_mov_b32 v38, 0
  v_mov_b32 v39, 0
  v_mov_b32 v40, 0
  v_mov_b32 v41, 0
  v_mov_b32 v42, 0
  v_mov_b32 v43, 0
  v_mov_b32 v44, 0
  v_mov_b32 v45, 0
  s_lshl_b32 s67, s60, 3
  s_waitcnt lgkmcnt(0)
  v_add_f32 v22, v22, v23
  v_add_f32 v24, v24, v25
  v_add_f32 v26, v26, v27
  v_add_f32 v28, v28, v29
  v_add_f32 v22, v22, v24
  v_add_f32 v26, v26, v28
  v_cvt_pk_bf16_f32 v22, v22, v22
  v_and_b32 v22, s69, v22
  v_cvt_pk_bf16_f32 v26, v26, v26
  v_and_b32 v26, s69, v26
  v_mul_f32 v22, 0xbfb8aa3b, v22
  v_exp_f32 v22, v22
  s_nop 0
  v_add_f32 v22, 1.0, v22
  v_rcp_f32 v22, v22
  s_nop 0
  v_cvt_pk_bf16_f32 v22, v22, v22
  v_and_b32 v22, s69, v22
  v_mul_f32 v22, v22, v26
  v_cvt_pk_bf16_f32 v22, v22, v22
  v_and_b32 v22, s69, v22
  s_nop 0
  v_readlane_b32 s72, v22, s67
  s_add_u32 s67, s67, 1
  v_readlane_b32 s73, v22, s67
  s_add_u32 s67, s67, 1
  v_readlane_b32 s74, v22, s67
  s_add_u32 s67, s67, 1
  v_readlane_b32 s75, v22, s67
  s_add_u32 s67, s67, 1
  v_readlane_b32 s76, v22, s67
  s_add_u32 s67, s67, 1
  v_readlane_b32 s77, v22, s67
  s_add_u32 s67, s67, 1
  v_readlane_b32 s78, v22, s67
  s_add_u32 s67, s67, 1
  v_readlane_b32 s79, v22, s67
  s_add_u32 s67, s67, 1
  s_nop 0
  v_lshlrev_b32 v30, 16, v48
  v_and_b32 v31, s69, v48
  v_lshlrev_b32 v32, 16, v49
  v_and_b32 v33, s69, v49
  v_lshlrev_b32 v34, 16, v50
  v_and_b32 v35, s69, v50
  v_lshlrev_b32 v36, 16, v51
  v_and_b32 v37, s69, v51
  v_pk_fma_f32 v[38:39], v[30:31], s[72:73], v[38:39] op_sel_hi:[1,0,1]
  v_pk_fma_f32 v[40:41], v[32:33], s[72:73], v[40:41] op_sel_hi:[1,0,1]
  v_pk_fma_f32 v[42:43], v[34:35], s[72:73], v[42:43] op_sel_hi:[1,0,1]
  v_pk_fma_f32 v[44:45], v[36:37], s[72:73], v[44:45] op_sel_hi:[1,0,1]
  v_lshlrev_b32 v30, 16, v52
  v_and_b32 v31, s69, v52
  v_lshlrev_b32 v32, 16, v53
  v_and_b32 v33, s69, v53
  v_lshlrev_b32 v34, 16, v54
  v_and_b32 v35, s69, v54
  v_lshlrev_b32 v36, 16, v55
  v_and_b32 v37, s69, v55
  v_pk_fma_f32 v[38:39], v[30:31], s[72:73], v[38:39] op_sel:[0,1,0] op_sel_hi:[1,1,1]
  v_pk_fma_f32 v[40:41], v[32:33], s[72:73], v[40:41] op_sel:[0,1,0] op_sel_hi:[1,1,1]
  v_pk_fma_f32 v[42:43], v[34:35], s[72:73], v[42:43] op_sel:[0,1,0] op_sel_hi:[1,1,1]
  v_pk_fma_f32 v[44:45], v[36:37], s[72:73], v[44:45] op_sel:[0,1,0] op_sel_hi:[1,1,1]
  v_lshlrev_b32 v30, 16, v56
  v_and_b32 v31, s69, v56
  v_lshlrev_b32 v32, 16, v57
  v_and_b32 v33, s69, v57
  v_lshlrev_b32 v34, 16, v58
  v_and_b32 v35, s69, v58
  v_lshlrev_b32 v36, 16, v59
  v_and_b32 v37, s69, v59
  v_pk_fma_f32 v[38:39], v[30:31], s[74:75], v[38:39] op_sel_hi:[1,0,1]
  v_pk_fma_f32 v[40:41], v[32:33], s[74:75], v[40:41] op_sel_hi:[1,0,1]
  v_pk_fma_f32 v[42:43], v[34:35], s[74:75], v[42:43] op_sel_hi:[1,0,1]
  v_pk_fma_f32 v[44:45], v[36:37], s[74:75], v[44:45] op_sel_hi:[1,0,1]
  v_lshlrev_b32 v30, 16, v60
  v_and_b32 v31, s69, v60
  v_lshlrev_b32 v32, 16, v61
  v_and_b32 v33, s69, v61
  v_lshlrev_b32 v34, 16, v62
  v_and_b32 v35, s69, v62
  v_lshlrev_b32 v36, 16, v63
  v_and_b32 v37, s69, v63
  v_pk_fma_f32 v[38:39], v[30:31], s[74:75], v[38:39] op_sel:[0,1,0] op_sel_hi:[1,1,1]
  v_pk_fma_f32 v[40:41], v[32:33], s[74:75], v[40:41] op_sel:[0,1,0] op_sel_hi:[1,1,1]
  v_pk_fma_f32 v[42:43], v[34:35], s[74:75], v[42:43] op_sel:[0,1,0] op_sel_hi:[1,1,1]
  v_pk_fma_f32 v[44:45], v[36:37], s[74:75], v[44:45] op_sel:[0,1,0] op_sel_hi:[1,1,1]
  buffer_load_dwordx4 v[48:51], v2, s[52:55], s91 offen offset:0
  buffer_load_dwordx4 v[52:55], v2, s[52:55], s91 offen offset:896
  buffer_load_dwordx4 v[56:59], v2, s[52:55], s91 offen offset:1792
  buffer_load_dwordx4 v[60:63], v2, s[52:55], s91 offen offset:2688
  ds_write_b128 v5, v[38:41] offset:22528
  ds_write_b128 v5, v[42:45] offset:22544
  s_branch L_jobret
L_job10:
  ds_read_b128 v[38:41], v5 offset:22528
  ds_read_b128 v[42:45], v5 offset:22544
  s_waitcnt lgkmcnt(0)
  v_lshlrev_b32 v30, 16, v48
  v_and_b32 v31, s69, v48
  v_lshlrev_b32 v32, 16, v49
  v_and_b32 v33, s69, v49
  v_lshlrev_b32 v34, 16, v50
  v_and_b32 v35, s69, v50
  v_lshlrev_b32 v36, 16, v51
  v_and_b32 v37, s69, v51
  v_pk_fma_f32 v[38:39], v[30:31], s[76:77], v[38:39] op_sel_hi:[1,0,1]
  v_pk_fma_f32 v[40:41], v[32:33], s[76:77], v[40:41] op_sel_hi:[1,0,1]
  v_pk_fma_f32 v[42:43], v[34:35], s[76:77], v[42:43] op_sel_hi:[1,0,1]
  v_pk_fma_f32 v[44:45], v[36:37], s[76:77], v[44:45] op_sel_hi:[1,0,1]
  v_lshlrev_b32 v30, 16, v52
  v_and_b32 v31, s69, v52
  v_lshlrev_b32 v32, 16, v53
  v_and_b32 v33, s69, v53
  v_lshlrev_b32 v34, 16, v54
  v_and_b32 v35, s69, v54
  v_lshlrev_b32 v36, 16, v55
  v_and_b32 v37, s69, v55
  v_pk_fma_f32 v[38:39], v[30:31], s[76:77], v[38:39] op_sel:[0,1,0] op_sel_hi:[1,1,1]
  v_pk_fma_f32 v[40:41], v[32:33], s[76:77], v[40:41] op_sel:[0,1,0] op_sel_hi:[1,1,1]
  v_pk_fma_f32 v[42:43], v[34:35], s[76:77], v[42:43] op_sel:[0,1,0] op_sel_hi:[1,1,1]
  v_pk_fma_f32 v[44:45], v[36:37], s[76:77], v[44:45] op_sel:[0,1,0] op_sel_hi:[1,1,1]
  v_lshlrev_b32 v30, 16, v56
  v_and_b32 v31, s69, v56
  v_lshlrev_b32 v32, 16, v57
  v_and_b32 v33, s69, v57
  v_lshlrev_b32 v34, 16, v58
  v_and_b32 v35, s69, v58
  v_lshlrev_b32 v36, 16, v59
  v_and_b32 v37, s69, v59
  v_pk_fma_f32 v[38:39], v[30:31], s[78:79], v[38:39] op_sel_hi:[1,0,1]
  v_pk_fma_f32 v[40:41], v[32:33], s[78:79], v[40:41] op_sel_hi:[1,0,1]
  v_pk_fma_f32 v[42:43], v[34:35], s[78:79], v[42:43] op_sel_hi:[1,0,1]
  v_pk_fma_f32 v[44:45], v[36:37], s[78:79], v[44:45] op_sel_hi:[1,0,1]
  v_lshlrev_b32 v30, 16, v60
  v_and_b32 v31, s69, v60
  v_lshlrev_b32 v32, 16, v61
  v_and_b32 v33, s69, v61
  v_lshlrev_b32 v34, 16, v62
  v_and_b32 v35, s69, v62
  v_lshlrev_b32 v36, 16, v63
  v_and_b32 v37, s69, v63
  v_pk_fma_f32 v[38:39], v[30:31], s[78:79], v[38:39] op_sel:[0,1,0] op_sel_hi:[1,1,1]
  v_pk_fma_f32 v[40:41], v[32:33], s[78:79], v[40:41] op_sel:[0,1,0] op_sel_hi:[1,1,1]
  v_pk_fma_f32 v[42:43], v[34:35], s[78:79], v[42:43] op_sel:[0,1,0] op_sel_hi:[1,1,1]
  v_pk_fma_f32 v[44:45], v[36:37], s[78:79], v[44:45] op_sel:[0,1,0] op_sel_hi:[1,1,1]
  ds_write_b128 v5, v[38:41] offset:22528
  ds_write_b128 v5, v[42:45] offset:22544
  s_branch L_jobret
L_epi:
  s_sub_u32 s67, s60, 5
  s_cmp_ge_u32 s67, 1
  s_cbranch_scc1 L_epi1
  s_lshl_b32 s67, s61, 4
  s_add_u32 s67, s67, 128
  v_mov_b32 v49, s67
  global_load_dword v48, v49, s[24:25] sc1
  v_and_b32 v52, 3, v1
  v_lshlrev_b32 v52, 3, v52
  s_mul_i32 s68, s61, 896
  s_add_u32 s44, s4, s68
  s_addc_u32 s45, s5, 0
  s_mov_b32 s46, 896
  s_mov_b32 s47, 0x00020000
  s_lshl_b32 s67, s64, 5
  buffer_load_dwordx2 v[50:51], v52, s[44:47], s67 offen
L_epi1:
  v_add_f32_dpp v21, v21, v21 row_ror:8 row_mask:0xf bank_mask:0xf
  v_permlane32_swap_b32 v12, v16
  v_permlane32_swap_b32 v13, v17
  v_permlane32_swap_b32 v14, v18
  v_permlane32_swap_b32 v15, v19
  v_add_f32_dpp v21, v21, v21 row_bcast:15 row_mask:0xa bank_mask:0xf
  v_add_f32 v12, v12, v16
  v_add_f32 v13, v13, v17
  v_add_f32 v14, v14, v18
  v_add_f32 v15, v15, v19
  v_add_f32_dpp v21, v21, v21 row_bcast:31 row_mask:0xc bank_mask:0xf
  s_mul_i32 s67, s60, 1040
  v_add_u32 v5, s67, v6
  ds_write_b128 v5, v[12:15] offset:38912
  s_lshl_b32 s67, s60, 3
  v_mov_b32 v5, s67
  s_lshl_b64 exec, 1, 63
  ds_write_b64 v5, v[20:21] offset:47232
  s_mov_b64 exec, -1
  v_and_b32 v22, 7, v1
  v_lshlrev_b32 v5, 3, v22
  v_mul_u32_u24 v22, 1040, v22
  v_lshrrev_b32 v23, 3, v1
  v_lshl_add_u32 v22, v23, 4, v22
  s_lshl_b32 s67, s60, 7
  v_add_u32 v22, s67, v22
  s_waitcnt lgkmcnt(0)
  s_barrier
  ds_read_b64 v[24:25], v5 offset:47232
  ds_read_b128 v[28:31], v22 offset:38912
  v_mov_b32 v32, 0
  v_mov_b32 v33, 0
  v_mov_b32 v34, 0
  v_mov_b32 v35, 0
  v_mov_b32 v36, 0
  v_mov_b32 v37, 0
  v_mov_b32 v38, 0
  v_mov_b32 v39, 0
  s_waitcnt lgkmcnt(1)
  v_max_f32_dpp v26, v24, v24 quad_perm:[1,0,3,2] row_mask:0xf bank_mask:0xf
  s_nop 1
  v_max_f32_dpp v26, v26, v26 quad_perm:[2,3,0,1] row_mask:0xf bank_mask:0xf
  s_nop 1
  v_max_f32_dpp v26, v26, v26 row_half_mirror row_mask:0xf bank_mask:0xf
  v_sub_f32 v24, v24, v26
  v_exp_f32 v24, v24
  s_waitcnt lgkmcnt(0)
  v_mul_f32 v27, v25, v24
  v_mul_f32 v28, v28, v24
  v_mul_f32 v29, v29, v24
  v_mul_f32 v30, v30, v24
  v_mul_f32 v31, v31, v24
  v_add_f32_dpp v27, v27, v27 quad_perm:[1,0,3,2] row_mask:0xf bank_mask:0xf
  v_add_f32_dpp v28, v28, v28 quad_perm:[1,0,3,2] row_mask:0xf bank_mask:0xf
  v_add_f32_dpp v29, v29, v29 quad_perm:[1,0,3,2] row_mask:0xf bank_mask:0xf
  v_add_f32_dpp v30, v30, v30 quad_perm:[1,0,3,2] row_mask:0xf bank_mask:0xf
  v_add_f32_dpp v31, v31, v31 quad_perm:[1,0,3,2] row_mask:0xf bank_mask:0xf
  v_add_f32_dpp v27, v27, v27 quad_perm:[2,3,0,1] row_mask:0xf bank_mask:0xf
  v_add_f32_dpp v28, v28, v28 quad_perm:[2,3,0,1] row_mask:0xf bank_mask:0xf
  v_add_f32_dpp v29, v29, v29 quad_perm:[2,3,0,1] row_mask:0xf bank_mask:0xf
  v_add_f32_dpp v30, v30, v30 quad_perm:[2,3,0,1] row_mask:0xf bank_mask:0xf
  v_add_f32_dpp v31, v31, v31 quad_perm:[2,3,0,1] row_mask:0xf bank_mask:0xf
  v_add_f32_dpp v27, v27, v27 row_half_mirror row_mask:0xf bank_mask:0xf
  v_add_f32_dpp v28, v28, v28 row_half_mirror row_mask:0xf bank_mask:0xf
  v_add_f32_dpp v29, v29, v29 row_half_mirror row_mask:0xf bank_mask:0xf
  v_add_f32_dpp v30, v30, v30 row_half_mirror row_mask:0xf bank_mask:0xf
  v_add_f32_dpp v31, v31, v31 row_half_mirror row_mask:0xf bank_mask:0xf
  v_cvt_pk_bf16_f32 v28, v28, v29
  v_cvt_pk_bf16_f32 v29, v30, v31
  s_nop 0
  v_readlane_b32 s72, v28, 0
  v_readlane_b32 s73, v29, 0
  v_readlane_b32 s74, v28, 8
  v_readlane_b32 s75, v29, 8
  v_readlane_b32 s76, v28, 16
  v_readlane_b32 s77, v29, 16
  v_readlane_b32 s78, v28, 24
  v_readlane_b32 s79, v29, 24
  v_readlane_b32 s80, v28, 32
  v_readlane_b32 s81, v29, 32
  v_readlane_b32 s82, v28, 40
  v_readlane_b32 s83, v29, 40
  v_readlane_b32 s84, v28, 48
  v_readlane_b32 s85, v29, 48
  v_readlane_b32 s86, v28, 56
  v_readlane_b32 s87, v29, 56
  v_lshlrev_b32 v5, 5, v1
  s_lshl_b32 s67, s60, 11
  v_add_u32 v5, s67, v5
  v_dot2c_f32_bf16 v32, s72, v128
  v_dot2c_f32_bf16 v33, s72, v129
  v_dot2c_f32_bf16 v34, s72, v130
  v_dot2c_f32_bf16 v35, s72, v131
  v_dot2c_f32_bf16 v36, s72, v132
  v_dot2c_f32_bf16 v37, s72, v133
  v_dot2c_f32_bf16 v38, s72, v134
  v_dot2c_f32_bf16 v39, s72, v135
  v_dot2c_f32_bf16 v32, s73, v136
  v_dot2c_f32_bf16 v33, s73, v137
  v_dot2c_f32_bf16 v34, s73, v138
  v_dot2c_f32_bf16 v35, s73, v139
  v_dot2c_f32_bf16 v36, s73, v140
  v_dot2c_f32_bf16 v37, s73, v141
  v_dot2c_f32_bf16 v38, s73, v142
  v_dot2c_f32_bf16 v39, s73, v143
  v_dot2c_f32_bf16 v32, s74, v144
  v_dot2c_f32_bf16 v33, s74, v145
  v_dot2c_f32_bf16 v34, s74, v146
  v_dot2c_f32_bf16 v35, s74, v147
  v_dot2c_f32_bf16 v36, s74, v148
  v_dot2c_f32_bf16 v37, s74, v149
  v_dot2c_f32_bf16 v38, s74, v150
  v_dot2c_f32_bf16 v39, s74, v151
  v_dot2c_f32_bf16 v32, s75, v152
  v_dot2c_f32_bf16 v33, s75, v153
  v_dot2c_f32_bf16 v34, s75, v154
  v_dot2c_f32_bf16 v35, s75, v155
  v_dot2c_f32_bf16 v36, s75, v156
  v_dot2c_f32_bf16 v37, s75, v157
  v_dot2c_f32_bf16 v38, s75, v158
  v_dot2c_f32_bf16 v39, s75, v159
  v_dot2c_f32_bf16 v32, s76, v160
  v_dot2c_f32_bf16 v33, s76, v161
  v_dot2c_f32_bf16 v34, s76, v162
  v_dot2c_f32_bf16 v35, s76, v163
  v_dot2c_f32_bf16 v36, s76, v164
  v_dot2c_f32_bf16 v37, s76, v165
  v_dot2c_f32_bf16 v38, s76, v166
  v_dot2c_f32_bf16 v39, s76, v167
  v_dot2c_f32_bf16 v32, s77, v168
  v_dot2c_f32_bf16 v33, s77, v169
  v_dot2c_f32_bf16 v34, s77, v170
  v_dot2c_f32_bf16 v35, s77, v171
  v_dot2c_f32_bf16 v36, s77, v172
  v_dot2c_f32_bf16 v37, s77, v173
  v_dot2c_f32_bf16 v38, s77, v174
  v_dot2c_f32_bf16 v39, s77, v175
  v_dot2c_f32_bf16 v32, s78, v176
  v_dot2c_f32_bf16 v33, s78, v177
  v_dot2c_f32_bf16 v34, s78, v178
  v_dot2c_f32_bf16 v35, s78, v179
  v_dot2c_f32_bf16 v36, s78, v180
  v_dot2c_f32_bf16 v37, s78, v181
  v_dot2c_f32_bf16 v38, s78, v182
  v_dot2c_f32_bf16 v39, s78, v183
  v_dot2c_f32_bf16 v32, s79, v184
  v_dot2c_f32_bf16 v33, s79, v185
  v_dot2c_f32_bf16 v34, s79, v186
  v_dot2c_f32_bf16 v35, s79, v187
  v_dot2c_f32_bf16 v36, s79, v188
  v_dot2c_f32_bf16 v37, s79, v189
  v_dot2c_f32_bf16 v38, s79, v190
  v_dot2c_f32_bf16 v39, s79, v191
  v_dot2c_f32_bf16 v32, s80, v192
  v_dot2c_f32_bf16 v33, s80, v193
  v_dot2c_f32_bf16 v34, s80, v194
  v_dot2c_f32_bf16 v35, s80, v195
  v_dot2c_f32_bf16 v36, s80, v196
  v_dot2c_f32_bf16 v37, s80, v197
  v_dot2c_f32_bf16 v38, s80, v198
  v_dot2c_f32_bf16 v39, s80, v199
  v_dot2c_f32_bf16 v32, s81, v200
  v_dot2c_f32_bf16 v33, s81, v201
  v_dot2c_f32_bf16 v34, s81, v202
  v_dot2c_f32_bf16 v35, s81, v203
  v_dot2c_f32_bf16 v36, s81, v204
  v_dot2c_f32_bf16 v37, s81, v205
  v_dot2c_f32_bf16 v38, s81, v206
  v_dot2c_f32_bf16 v39, s81, v207
  v_dot2c_f32_bf16 v32, s82, v208
  v_dot2c_f32_bf16 v33, s82, v209
  v_dot2c_f32_bf16 v34, s82, v210
  v_dot2c_f32_bf16 v35, s82, v211
  v_dot2c_f32_bf16 v36, s82, v212
  v_dot2c_f32_bf16 v37, s82, v213
  v_dot2c_f32_bf16 v38, s82, v214
  v_dot2c_f32_bf16 v39, s82, v215
  v_dot2c_f32_bf16 v32, s83, v216
  v_dot2c_f32_bf16 v33, s83, v217
  v_dot2c_f32_bf16 v34, s83, v218
  v_dot2c_f32_bf16 v35, s83, v219
  v_dot2c_f32_bf16 v36, s83, v220
  v_dot2c_f32_bf16 v37, s83, v221
  v_dot2c_f32_bf16 v38, s83, v222
  v_dot2c_f32_bf16 v39, s83, v223
  v_dot2c_f32_bf16 v32, s84, v224
  v_dot2c_f32_bf16 v33, s84, v225
  v_dot2c_f32_bf16 v34, s84, v226
  v_dot2c_f32_bf16 v35, s84, v227
  v_dot2c_f32_bf16 v36, s84, v228
  v_dot2c_f32_bf16 v37, s84, v229
  v_dot2c_f32_bf16 v38, s84, v230
  v_dot2c_f32_bf16 v39, s84, v231
  v_dot2c_f32_bf16 v32, s85, v232
  v_dot2c_f32_bf16 v33, s85, v233
  v_dot2c_f32_bf16 v34, s85, v234
  v_dot2c_f32_bf16 v35, s85, v235
  v_dot2c_f32_bf16 v36, s85, v236
  v_dot2c_f32_bf16 v37, s85, v237
  v_dot2c_f32_bf16 v38, s85, v238
  v_dot2c_f32_bf16 v39, s85, v239
  v_dot2c_f32_bf16 v32, s86, v240
  v_dot2c_f32_bf16 v33, s86, v241
  v_dot2c_f32_bf16 v34, s86, v242
  v_dot2c_f32_bf16 v35, s86, v243
  v_dot2c_f32_bf16 v36, s86, v244
  v_dot2c_f32_bf16 v37, s86, v245
  v_dot2c_f32_bf16 v38, s86, v246
  v_dot2c_f32_bf16 v39, s86, v247
  v_dot2c_f32_bf16 v32, s87, v248
  v_dot2c_f32_bf16 v33, s87, v249
  v_dot2c_f32_bf16 v34, s87, v250
  v_dot2c_f32_bf16 v35, s87, v251
  v_dot2c_f32_bf16 v36, s87, v252
  v_dot2c_f32_bf16 v37, s87, v253
  v_dot2c_f32_bf16 v38, s87, v254
  v_dot2c_f32_bf16 v39, s87, v255
  s_nop 3
  ds_write_b128 v5, v[32:35] offset:47872
  ds_write_b128 v5, v[36:39] offset:47888
  s_waitcnt lgkmcnt(0)
  s_barrier
  s_sub_u32 s67, s60, 5
  s_cmp_lt_u32 s67, 1
  s_cbranch_scc1 L_cons
  s_cmp_gt_u32 s60, 4
  s_cbranch_scc1 L_fin
  s_cmp_eq_u32 s60, 4
  s_cbranch_scc1 L_stml
  s_and_b32 s67, s60, 1
  s_lshl_b32 s67, s67, 10
  v_add_u32 v5, s67, v2
  s_lshr_b32 s68, s60, 1
  s_mov_b32 s67, 47872
  s_cmp_eq_u32 s68, 0
  s_cselect_b32 s67, s67, 22528
  v_add_u32 v22, s67, v5
  ds_read_b128 v[24:27], v22 offset:0
  ds_read_b128 v[28:31], v22 offset:2048
  ds_read_b128 v[32:35], v22 offset:4096
  ds_read_b128 v[36:39], v22 offset:6144
  ds_read_b128 v[40:43], v22 offset:8192
  ds_read_b128 v[44:47], v22 offset:10240
  ds_read_b128 v[48:51], v22 offset:12288
  ds_read_b128 v[52:55], v22 offset:14336
  s_mul_i32 s68, s68, 1792
  s_add_u32 s67, s95, s68
  v_cmp_gt_u32 vcc, 1792, v5
  s_waitcnt lgkmcnt(6)
  v_pk_add_f32 v[24:25], v[24:25], v[28:29]
  v_pk_add_f32 v[26:27], v[26:27], v[30:31]
  s_waitcnt lgkmcnt(5)
  v_pk_add_f32 v[24:25], v[24:25], v[32:33]
  v_pk_add_f32 v[26:27], v[26:27], v[34:35]
  s_waitcnt lgkmcnt(4)
  v_pk_add_f32 v[24:25], v[24:25], v[36:37]
  v_pk_add_f32 v[26:27], v[26:27], v[38:39]
  s_waitcnt lgkmcnt(3)
  v_pk_add_f32 v[24:25], v[24:25], v[40:41]
  v_pk_add_f32 v[26:27], v[26:27], v[42:43]
  s_waitcnt lgkmcnt(2)
  v_pk_add_f32 v[24:25], v[24:25], v[44:45]
  v_pk_add_f32 v[26:27], v[26:27], v[46:47]
  s_waitcnt lgkmcnt(1)
  v_pk_add_f32 v[24:25], v[24:25], v[48:49]
  v_pk_add_f32 v[26:27], v[26:27], v[50:51]
  s_waitcnt lgkmcnt(0)
  v_pk_add_f32 v[24:25], v[24:25], v[52:53]
  v_pk_add_f32 v[26:27], v[26:27], v[54:55]
  s_and_saveexec_b64 s[100:101], vcc
  buffer_store_dwordx4 v[24:27], v5, s[56:59], s67 offen sc1
  s_mov_b64 exec, -1
  s_branch L_fin
L_stml:
  v_mov_b32 v5, 3584
  s_mov_b64 exec, 1
  buffer_store_dwordx2 v[26:27], v5, s[56:59], s95 offen sc1
  s_mov_b64 exec, -1
  s_branch L_fin
L_cons:
  s_cmp_ge_u32 s64, 28
  s_cbranch_scc1 L_fin
  v_lshrrev_b32 v23, 2, v1
  v_lshlrev_b32 v23, 12, v23
  v_and_b32 v22, 3, v1
  v_lshl_add_u32 v22, v22, 4, v23
  s_lshl_b32 s67, s61, 17
  s_lshl_b32 s68, s64, 6
  s_add_u32 s68, s68, s67
  s_add_u32 s70, s68, 0x10000
  s_add_u32 s71, s67, 0x10000
  s_mov_b32 s65, 0
  s_waitcnt vmcnt(0)
L_clrchk:
  v_cmp_gt_u32 vcc, 32, v48
  s_cbranch_vccz L_poll0
  s_sleep 8
  global_load_dword v48, v49, s[24:25] sc1
  s_add_u32 s65, s65, 1
  s_cmp_lt_u32 s65, 2097152
  s_waitcnt vmcnt(0)
  s_cbranch_scc1 L_clrchk
L_poll0:
  s_mov_b64 s[72:73], -1
  s_mov_b64 s[74:75], -1
  s_mov_b64 s[76:77], -1
  s_mov_b64 s[78:79], -1
  s_mov_b64 s[80:81], -1
  s_mov_b64 s[82:83], -1
  s_mov_b32 s65, 0
L_poll:
  s_mov_b64 exec, s[72:73]
  s_cbranch_execz L_skip0
  buffer_load_dwordx4 v[24:27], v22, s[56:59], s68 offen offset:0 sc1
L_skip0:
  s_mov_b64 exec, s[74:75]
  s_cbranch_execz L_skip1
  buffer_load_dwordx4 v[28:31], v22, s[56:59], s70 offen offset:0 sc1
L_skip1:
  s_mov_b64 exec, s[76:77]
  s_cbranch_execz L_skip2
  buffer_load_dwordx4 v[32:35], v22, s[56:59], s68 offen offset:1792 sc1
L_skip2:
  s_mov_b64 exec, s[78:79]
  s_cbranch_execz L_skip3
  buffer_load_dwordx4 v[36:39], v22, s[56:59], s70 offen offset:1792 sc1
L_skip3:
  s_mov_b64 exec, s[80:81]
  s_cbranch_execz L_skip4
  buffer_load_dwordx2 v[40:41], v23, s[56:59], s67 offen offset:3584 sc1
L_skip4:
  s_mov_b64 exec, s[82:83]
  s_cbranch_execz L_skip5
  buffer_load_dwordx2 v[42:43], v23, s[56:59], s71 offen offset:3584 sc1
L_skip5:
  s_mov_b64 exec, -1
  s_waitcnt vmcnt(0)
  v_max3_u32 v44, v24, v25, v26
  v_max_u32 v44, v44, v27
  v_cmp_eq_u32 s[72:73], -1, v44
  v_max3_u32 v44, v28, v29, v30
  v_max_u32 v44, v44, v31
  v_cmp_eq_u32 s[74:75], -1, v44
  v_max3_u32 v44, v32, v33, v34
  v_max_u32 v44, v44, v35
  v_cmp_eq_u32 s[76:77], -1, v44
  v_max3_u32 v44, v36, v37, v38
  v_max_u32 v44, v44, v39
  v_cmp_eq_u32 s[78:79], -1, v44
  v_max_u32 v44, v40, v41
  v_cmp_eq_u32 s[80:81], -1, v44
  v_max_u32 v44, v42, v43
  v_cmp_eq_u32 s[82:83], -1, v44
  s_nop 1
  s_or_b64 s[100:101], s[72:73], s[74:75]
  s_or_b64 s[100:101], s[100:101], s[76:77]
  s_or_b64 s[100:101], s[100:101], s[78:79]
  s_or_b64 s[100:101], s[100:101], s[80:81]
  s_or_b64 s[100:101], s[100:101], s[82:83]
  s_cbranch_scc0 L_ready
  s_add_u32 s65, s65, 1
  s_cmp_lt_u32 s65, 2097152
  s_sleep 1
  s_cbranch_scc1 L_poll
L_ready:
  v_max_f32_dpp v44, v40, v40 row_half_mirror row_mask:0xf bank_mask:0xf
  v_max_f32_dpp v45, v42, v42 row_half_mirror row_mask:0xf bank_mask:0xf
  v_sub_f32 v40, v40, v44
  v_sub_f32 v42, v42, v45
  v_exp_f32 v40, v40
  v_exp_f32 v42, v42
  s_nop 0
  v_mul_f32 v41, v41, v40
  v_mul_f32 v43, v43, v42
  s_nop 0
  v_add_f32_dpp v41, v41, v41 row_half_mirror row_mask:0xf bank_mask:0xf
  v_add_f32_dpp v43, v43, v43 row_half_mirror row_mask:0xf bank_mask:0xf
  v_rcp_f32 v41, v41
  v_rcp_f32 v43, v43
  v_pk_add_f32 v[32:33], v[32:33], v[36:37]
  v_pk_add_f32 v[34:35], v[34:35], v[38:39]
  v_mul_f32 v40, v40, v41
  v_mul_f32 v42, v42, v43
  v_pk_mul_f32 v[24:25], v[24:25], v[40:41] op_sel_hi:[1,0]
  v_pk_mul_f32 v[26:27], v[26:27], v[40:41] op_sel_hi:[1,0]
  v_pk_fma_f32 v[24:25], v[28:29], v[42:43], v[24:25] op_sel_hi:[1,0,1]
  v_pk_fma_f32 v[26:27], v[30:31], v[42:43], v[26:27] op_sel_hi:[1,0,1]
  v_add_f32_dpp v32, v32, v32 row_ror:4 row_mask:0xf bank_mask:0xf
  v_add_f32_dpp v33, v33, v33 row_ror:4 row_mask:0xf bank_mask:0xf
  v_add_f32_dpp v34, v34, v34 row_ror:4 row_mask:0xf bank_mask:0xf
  v_add_f32_dpp v35, v35, v35 row_ror:4 row_mask:0xf bank_mask:0xf
  v_add_f32_dpp v24, v24, v24 row_ror:4 row_mask:0xf bank_mask:0xf
  v_add_f32_dpp v25, v25, v25 row_ror:4 row_mask:0xf bank_mask:0xf
  v_add_f32_dpp v26, v26, v26 row_ror:4 row_mask:0xf bank_mask:0xf
  v_add_f32_dpp v27, v27, v27 row_ror:4 row_mask:0xf bank_mask:0xf
  v_add_f32_dpp v32, v32, v32 row_ror:8 row_mask:0xf bank_mask:0xf
  v_add_f32_dpp v33, v33, v33 row_ror:8 row_mask:0xf bank_mask:0xf
  v_add_f32_dpp v34, v34, v34 row_ror:8 row_mask:0xf bank_mask:0xf
  v_add_f32_dpp v35, v35, v35 row_ror:8 row_mask:0xf bank_mask:0xf
  v_add_f32_dpp v24, v24, v24 row_ror:8 row_mask:0xf bank_mask:0xf
  v_add_f32_dpp v25, v25, v25 row_ror:8 row_mask:0xf bank_mask:0xf
  v_add_f32_dpp v26, v26, v26 row_ror:8 row_mask:0xf bank_mask:0xf
  v_add_f32_dpp v27, v27, v27 row_ror:8 row_mask:0xf bank_mask:0xf
  s_nop 0
  v_permlane32_swap_b32 v24, v32
  v_permlane32_swap_b32 v25, v33
  v_permlane32_swap_b32 v26, v34
  v_permlane32_swap_b32 v27, v35
  s_nop 0
  v_add_f32 v24, v24, v32
  v_add_f32 v25, v25, v33
  v_add_f32 v26, v26, v34
  v_add_f32 v27, v27, v35
  v_mov_b32 v32, v24
  v_mov_b32 v33, v25
  v_mov_b32 v34, v26
  v_mov_b32 v35, v27
  s_nop 0
  v_permlane16_swap_b32 v24, v32
  v_permlane16_swap_b32 v25, v33
  v_permlane16_swap_b32 v26, v34
  v_permlane16_swap_b32 v27, v35
  s_nop 0
  v_add_f32 v24, v24, v32
  v_add_f32 v25, v25, v33
  v_add_f32 v26, v26, v34
  v_add_f32 v27, v27, v35
  v_cvt_pk_bf16_f32 v24, v24, v24
  v_and_b32 v24, s69, v24
  v_cvt_pk_bf16_f32 v25, v25, v25
  v_and_b32 v25, s69, v25
  v_cvt_pk_bf16_f32 v26, v26, v26
  v_and_b32 v26, s69, v26
  v_cvt_pk_bf16_f32 v27, v27, v27
  v_and_b32 v27, s69, v27
  v_mov_b32 v32, v24
  v_mov_b32 v33, v25
  v_mov_b32 v34, v26
  v_mov_b32 v35, v27
  v_lshlrev_b32 v28, 16, v50
  v_and_b32 v29, s69, v50
  v_permlane32_swap_b32 v24, v32
  v_permlane32_swap_b32 v25, v33
  v_permlane32_swap_b32 v26, v34
  v_permlane32_swap_b32 v27, v35
  v_lshlrev_b32 v30, 16, v51
  v_and_b32 v31, s69, v51
  v_add_f32 v24, v24, v28
  v_add_f32 v25, v25, v29
  v_add_f32 v26, v26, v30
  v_add_f32 v27, v27, v31
  v_cvt_pk_bf16_f32 v24, v24, v24
  v_and_b32 v24, s69, v24
  v_cvt_pk_bf16_f32 v25, v25, v25
  v_and_b32 v25, s69, v25
  v_cvt_pk_bf16_f32 v26, v26, v26
  v_and_b32 v26, s69, v26
  v_cvt_pk_bf16_f32 v27, v27, v27
  v_and_b32 v27, s69, v27
  v_add_f32 v24, v24, v32
  v_add_f32 v25, v25, v33
  v_add_f32 v26, v26, v34
  v_add_f32 v27, v27, v35
  v_cvt_pk_bf16_f32 v24, v24, v25
  v_cvt_pk_bf16_f32 v25, v26, v27
  s_mul_i32 s68, s61, 896
  s_add_u32 s40, s22, s68
  s_addc_u32 s41, s23, 0
  s_mov_b32 s42, 896
  s_mov_b32 s43, 0x00020000
  s_lshl_b32 s67, s64, 5
  s_mov_b64 exec, 15
  buffer_store_dwordx2 v[24:25], v52, s[40:43], s67 offen sc1
  s_mov_b64 exec, -1
L_fin:
L_end:
  s_endpgm
.section .rodata,"a"
.p2align 6
.amdhsa_kernel parallel_sum__mha_block_cached__glu_gated_glu__decode_kernel
  .amdhsa_next_free_vgpr 256
  .amdhsa_next_free_sgpr 102
  .amdhsa_accum_offset 256
  .amdhsa_group_segment_fixed_size 0
  .amdhsa_kernarg_size 96
  .amdhsa_user_sgpr_count 2
  .amdhsa_user_sgpr_kernarg_segment_ptr 1
  .amdhsa_system_sgpr_workgroup_id_x 1
.end_amdhsa_kernel
```
